```python
import torch

def _softmax(x, axis=-1):
    return torch.softmax(x, dim=axis)
def _gelu(x):
    return torch.nn.functional.gelu(x, approximate="tanh")
def _silu(x):
    return torch.nn.functional.silu(x)
def _sigmoid(x):
    return torch.sigmoid(x)
def _layernorm(x, axis=-1, eps=1e-5):
    m = x.mean(dim=axis, keepdim=True)
    v = x.var(dim=axis, keepdim=True, unbiased=False)
    return (x - m) / torch.sqrt(v + eps)
def _scatter_add(tgt, idx, src, axis=0):
    return tgt.clone().index_add_(axis, idx, src)
def _segment_sum(src, seg, n):
    out = torch.zeros((n,) + src.shape[1:], dtype=src.dtype)
    return out.index_add_(0, seg, src)
def _pad(x, pw):
    flat = tuple(v for pair in reversed(pw) for v in pair)
    return torch.nn.functional.pad(x, flat)

kernel_name = 'gated_mix__ssm_conv_h3__ssm_conv_s4__prompt'

def setup_inputs():

    _w = (lambda a: (lambda t: t.to(torch.bfloat16) if t.is_floating_point() else t)(torch.as_tensor(a)))
    def _A_setup():
        B, S, D = 1, 2048, 512
        ks = 4
        return {
            "q": _w((lambda *s: torch.randn(*s, dtype=torch.bfloat16) * 0.05)(B, S, D)),
            "k": _w((lambda *s: torch.randn(*s, dtype=torch.bfloat16) * 0.4)(B, S, D)),
            "v": _w((lambda *s: torch.randn(*s, dtype=torch.bfloat16) * 0.2)(B, S, D)),
            "shift_k": _w((lambda *s: torch.randn(*s, dtype=torch.bfloat16) * 0.4)(D, ks) * 0.5),
            "ssm_k": _w((lambda *s: torch.randn(*s, dtype=torch.bfloat16) * 0.4)(D, S) * (1.0 / S ** 0.5)),
            "ssm_D": _w((lambda *s: torch.randn(*s, dtype=torch.bfloat16) * 0.2)(D)),
        }
    _A_in = _A_setup()

    def _B_setup():
        B, L, D, N = 1, 2048, 512, 128
        A_re = -(lambda _x: torch.exp(torch.as_tensor(_x)))((lambda *s: torch.randn(*s, dtype=torch.bfloat16) * 3.2)(D, N))
        A_im = torch.pi * (lambda *s: torch.randn(*s, dtype=torch.bfloat16) * 0.05)(D, N)
        B_re = (lambda *s: torch.randn(*s, dtype=torch.bfloat16) * 0.1)(D, N)
        B_im = (lambda *s: torch.randn(*s, dtype=torch.bfloat16) * 0.1)(D, N)
        C_re = (lambda *s: torch.randn(*s, dtype=torch.bfloat16) * 0.1)(D, N)
        C_im = (lambda *s: torch.randn(*s, dtype=torch.bfloat16) * 0.1)(D, N)
        log_dt = (lambda *s: torch.randn(*s, dtype=torch.bfloat16) * 0.05)(D) * 0.5 - 4.0
        Dskip = (lambda *s: torch.randn(*s, dtype=torch.bfloat16) * 0.05)(D)
        return {
            "u": _w((lambda *s: torch.randn(*s, dtype=torch.bfloat16) * 0.05)(B, L, D)),
            "A_re": _w(A_re),
            "A_im": _w(A_im),
            "B_re": _w(B_re),
            "B_im": _w(B_im),
            "C_re": _w(C_re),
            "C_im": _w(C_im),
            "log_dt": _w(log_dt),
            "Dskip": _w(Dskip),
        }
    _B_in = _B_setup()

    return {
        "A_q": _A_in["q"],
        "A_k": _A_in["k"],
        "A_v": _A_in["v"],
        "A_shift_k": _A_in["shift_k"],
        "A_ssm_k": _A_in["ssm_k"],
        "A_ssm_D": _A_in["ssm_D"],
        "B_u": _B_in["u"],
        "B_A_re": _B_in["A_re"],
        "B_A_im": _B_in["A_im"],
        "B_B_re": _B_in["B_re"],
        "B_B_im": _B_in["B_im"],
        "B_C_re": _B_in["C_re"],
        "B_C_im": _B_in["C_im"],
        "B_log_dt": _B_in["log_dt"],
        "B_Dskip": _B_in["Dskip"],
        "gate_w": _w((lambda *s: torch.randn(*s, dtype=torch.bfloat16) * 0.05)(512) * 16.0),
    }

def reference(A_q, A_k, A_v, A_shift_k, A_ssm_k, A_ssm_D, B_u, B_A_re, B_A_im, B_B_re, B_B_im, B_C_re, B_C_im, B_log_dt, B_Dskip, gate_w):
    def _A_ref(q, k, v, shift_k, ssm_k, ssm_D):
        B, S, D = q.shape
        ks = shift_k.shape[-1]
        k_pad = _pad(k, ((0, 0), (ks - 1, 0), (0, 0)))
        k_shift = torch.zeros_like(k)
        for t in range(ks):
            k_shift = k_shift + k_pad[:, t:t + S, :] * shift_k[:, ks - 1 - t][None, None, :]
        kv = k_shift * v
        L = 2 * S
        kv_pad = _pad(kv, ((0, 0), (0, S), (0, 0)))
        kf_pad = _pad(ssm_k, ((0, 0), (0, S)))
        kv_f = (lambda x, axes=(-2,-1): torch.fft.rfft2(x.float(), dim=axes))(kv_pad[:, None, :, :], axes=(1, 2))
        kf_f = (lambda x, axes=(-2,-1): torch.fft.rfft2(x.float(), dim=axes))(kf_pad[:, None, :], axes=(1, 2))
        kf_f = (lambda x, *d: x.permute(*d))(kf_f, 1, 2, 0)
        y_f = kv_f * kf_f[None, :, :, :]
        y = (lambda x, s, axes=(-2,-1): torch.fft.irfft2(x, s=s, dim=axes).to(torch.bfloat16))(y_f, (1, L), axes=(1, 2))[:, 0, :S, :]
        y = y + kv * ssm_D[None, None, :]
        return q * y

    def _B_ref(u, A_re, A_im, B_re, B_im, C_re, C_im, log_dt, Dskip):
        Bsz, L, D = u.shape
        dt = torch.exp(log_dt)[:, None]
        A = A_re + 1j * A_im
        Bc = B_re + 1j * B_im
        Cc = C_re + 1j * C_im
        logdA = dt * A
        dB = dt * Bc
        l = (lambda x, dt: x.to(dt))(torch.arange(L), A_re.dtype)
        P = torch.exp(logdA[:, :, None] * l[None, None, :])
        K = torch.einsum("dn,dnl,dn->dl", Cc, P, dB).real
        L2 = 2 * L
        Kp = _pad(K, ((0, 0), (0, L)))
        up = (lambda x, *d: x.permute(*d))(u, 0, 2, 1)
        up = _pad(up, ((0, 0), (0, 0), (0, L)))
        Kf = (lambda x, axes=(-2,-1): torch.fft.rfft2(x.float(), dim=axes))(Kp[:, None, :], axes=(-2, -1))
        Uf = (lambda x, axes=(-2,-1): torch.fft.rfft2(x.float(), dim=axes))(up[:, :, None, :], axes=(-2, -1))
        Yf = Uf * Kf[None, :, :, :]
        y = (lambda x, s, axes=(-2,-1): torch.fft.irfft2(x, s=s, dim=axes).to(torch.bfloat16))(Yf, (1, L2), axes=(-2, -1))[:, :, 0, :L]
        y = (lambda x, *d: x.permute(*d))(y, 0, 2, 1) + u * Dskip[None, None, :]
        return y

    x = A_q
    g = _sigmoid((x * gate_w).sum(-1, keepdims=True))
    a = _A_ref(x, A_k, A_v, A_shift_k, A_ssm_k, A_ssm_D)
    b = _B_ref(x, B_A_re, B_A_im, B_B_re, B_B_im, B_C_re, B_C_im, B_log_dt, B_Dskip)
    return g * a + (1 - g) * b
```

```asm
; @launch grid=(256,1,1) block=(512,1,1) lds=153088
.amdgcn_target "amdgcn-amd-amdhsa--gfx950"
.text
.globl gated_mix__ssm_conv_h3__ssm_conv_s4__prompt_kernel
.p2align 8
.type gated_mix__ssm_conv_h3__ssm_conv_s4__prompt_kernel,@function
gated_mix__ssm_conv_h3__ssm_conv_s4__prompt_kernel:
  s_cmp_ge_u32 s2, 256
  s_cbranch_scc1 L_END
  s_load_dwordx16 s[16:31], s[0:1], 0
  s_load_dwordx16 s[32:47], s[0:1], 64
  s_load_dwordx4 s[48:51], s[0:1], 128
  s_load_dwordx2 s[52:53], s[0:1], 144
  v_lshrrev_b32 v1, 6, v0
  v_and_b32 v2, 63, v0
  v_readfirstlane_b32 s3, v1
  s_and_b32 s4, s2, 7
  s_lshr_b32 s5, s2, 3
  s_nop 1
  s_cmp_eq_u32 s3, 0
  s_cbranch_scc0 L_NOPF
  s_getpc_b64 s[74:75]
L_PC:
  .set CODE_REM, L_CODE_END - L_PC
  s_mul_i32 s76, s5, 5
  v_add_u32 v74, s76, v2
  v_lshlrev_b32 v74, 7, v74
  v_cmp_gt_u32 vcc, CODE_REM, v74
  s_nop 1
  v_cndmask_b32 v74, 0, v74, vcc
  s_mov_b64 exec, 31
  global_load_dword v30, v74, s[74:75]
  s_mov_b64 exec, -1
L_NOPF:
  s_lshl_b32 s10, s4, 6
  s_lshl_b32 s11, s5, 1
  s_add_u32 s10, s10, s11
  s_and_b32 s96, s3, 3
  s_lshr_b32 s7, s3, 2
  s_xor_b32 s6, s96, s7
  s_and_b32 s8, s6, 1
  s_lshr_b32 s9, s6, 1
  v_lshlrev_b32 v69, 4, v2
  s_lshl_b32 s11, s5, 16
  s_lshl_b32 s12, s4, 7
  s_add_u32 s11, s11, s12
  s_getreg_b32 s97, hwreg(HW_REG_XCC_ID, 0, 4)
  s_cmp_eq_u32 s7, 0
  s_cbranch_scc1 L_KISSUE
  v_lshrrev_b32 v67, 3, v2
  v_and_b32 v68, 7, v2
  v_lshlrev_b32 v5, 10, v67
  v_lshl_add_u32 v5, v68, 4, v5
  s_lshl_b32 s12, s96, 14
  s_add_u32 s12, s12, s11
  v_add_u32 v5, s12, v5
  v_add_u32 v7, 8192, v5
  v_subrev_u32 v6, 8192, v5
  v_bfe_u32 v70, v0, 3, 5
  v_and_b32 v71, 7, v0
  v_lshlrev_b32 v72, 11, v70
  v_lshl_add_u32 v72, v71, 4, v72
  v_add_u32 v72, s11, v72
  s_lshl_b32 s14, s4, 9
  v_add_u32 v73, s14, v69
  s_lshl_b32 s13, s96, 11
  s_waitcnt lgkmcnt(0)
  s_mov_b32 s56, s18
  s_and_b32 s57, s19, 0xffff
  s_mov_b32 s58, 0x200000
  s_mov_b32 s59, 0x20000
  s_cmp_eq_u32 s3, 4
  s_cbranch_scc0 L_X1
  s_mov_b32 m0, 0
  s_nop 0
  buffer_load_dwordx4 v6, s[56:59], 0 offen lds
  s_branch L_X2
L_X1:
  s_cmp_eq_u32 s3, 5
  s_cbranch_scc0 L_X2
  s_mov_b32 exec_hi, 0
  s_mov_b32 m0, 25600
  s_nop 0
  global_load_lds_dwordx4 v73, s[22:23]
  s_mov_b32 exec_hi, -1
L_X2:
  s_add_u32 m0, s13, 1024
  s_nop 0
  buffer_load_dwordx4 v5, s[56:59], 0 offen lds
  s_add_u32 m0, s13, 2048
  s_nop 0
  buffer_load_dwordx4 v7, s[56:59], 0 offen lds
  global_load_dwordx4 v[120:123], v72, s[20:21]
  global_load_dwordx4 v[124:127], v72, s[20:21] offset:1024
  s_add_u32 m0, s13, 9216
  s_nop 0
  global_load_lds_dwordx4 v5, s[16:17]
  s_add_u32 m0, s13, 10240
  s_nop 0
  global_load_lds_dwordx4 v7, s[16:17]
  s_branch L_COMMON
L_KISSUE:
  s_lshl_b32 s15, s10, 8
  v_add_u32 v72, s15, v69
  s_lshl_b32 s12, s2, 3
  s_lshl_b32 s13, s96, 1
  s_add_u32 s12, s12, s13
  s_lshl_b32 s13, s12, 10
  v_add_u32 v73, s13, v69
  s_lshl_b32 s79, s10, 1
  s_waitcnt lgkmcnt(0)
  s_load_dword s76, s[42:43], s79
  s_mov_b32 exec_hi, 0
  s_cmp_eq_u32 s96, 0
  s_cbranch_scc0 L_KP0
  s_mov_b32 m0, 26112
  s_nop 0
  global_load_lds_dwordx4 v72, s[30:31]
  s_mov_b32 m0, 26624
  s_nop 0
  global_load_lds_dwordx4 v72, s[32:33]
  s_branch L_KP4
L_KP0:
  s_cmp_eq_u32 s96, 1
  s_cbranch_scc0 L_KP1
  s_mov_b32 m0, 27136
  s_nop 0
  global_load_lds_dwordx4 v72, s[34:35]
  s_mov_b32 m0, 27648
  s_nop 0
  global_load_lds_dwordx4 v72, s[36:37]
  s_branch L_KP4
L_KP1:
  s_cmp_eq_u32 s96, 2
  s_cbranch_scc0 L_KP2
  s_mov_b32 m0, 28160
  s_nop 0
  global_load_lds_dwordx4 v72, s[38:39]
  s_branch L_KP4
L_KP2:
  s_cmp_eq_u32 s96, 3
  s_cbranch_scc0 L_KP3
  s_mov_b32 m0, 28672
  s_nop 0
  global_load_lds_dwordx4 v72, s[40:41]
  s_branch L_KP4
L_KP3:
L_KP4:
  s_mov_b64 exec, -1
  global_load_dwordx4 v[100:103], v73, s[16:17]
  global_load_dwordx4 v[104:107], v73, s[16:17] offset:1024
  global_load_dwordx4 v[108:111], v69, s[46:47]
  s_cmp_eq_u32 s3, 3
  s_cbranch_scc0 L_COMMON
  v_subrev_u32 v74, 1, v2
  v_lshlrev_b32 v74, 21, v74
  v_mov_b32 v75, 8650752
  v_cmp_eq_u32 vcc, 0, v2
  s_nop 1
  v_cndmask_b32 v74, v74, v75, vcc
  s_mov_b64 exec, 7
  global_load_dword v30, v74, s[52:53] sc1
  s_mov_b64 exec, -1
L_COMMON:
  s_mov_b32 s60, s52
  s_and_b32 s61, s53, 0xffff
  s_mov_b32 s62, 8654848
  s_mov_b32 s63, 0x20000
  s_mov_b32 s64, s48
  s_and_b32 s65, s49, 0xffff
  s_mov_b32 s66, 0x200000
  s_mov_b32 s67, 0x20000
  s_mov_b32 s68, s24
  s_and_b32 s69, s25, 0xffff
  s_mov_b32 s70, 0x200000
  s_mov_b32 s71, 0x20000
  s_lshl_b32 s79, s10, 1
  s_load_dword s76, s[42:43], s79
  s_load_dword s100, s[26:27], s79
  s_load_dword s101, s[44:45], s79
  v_mov_b32 v21, 0x3f803f80
  v_mov_b32 v28, 0xffff
  v_mov_b32 v27, 0xffff0000
  v_and_b32 v64, 15, v2
  v_lshrrev_b32 v65, 4, v2
  s_lshl_b32 s13, s10, 12
  v_lshlrev_b32 v4, 4, v0
  v_add_u32 v13, s13, v4
  s_mul_i32 s77, s6, 4608
  s_add_u32 s77, s77, 74752
  s_lshl_b32 s78, s7, 8
  s_add_u32 s78, s78, s77
  s_add_u32 s78, s78, 480
  v_lshlrev_b32 v62, 5, v64
  v_lshlrev_b32 v8, 4, v65
  v_sub_u32 v8, v8, v62
  v_add_u32 v8, s78, v8
  v_lshl_add_u32 v63, v65, 3, v62
  s_add_u32 s78, s77, 504
  v_sub_u32 v9, s78, v63
  s_add_u32 s78, s77, 4096
  v_lshlrev_b32 v29, 3, v2
  v_add_u32 v29, s78, v29
  s_or_b32 s78, s6, 1
  s_mul_i32 s78, s78, 4608
  s_add_u32 s78, s78, 75256
  v_sub_u32 v10, s78, v63
  v_lshlrev_b32 v62, 1, v63
  v_add_u32 v11, 93184, v62
  s_lshl_b32 s78, s6, 13
  s_add_u32 s78, s78, 101376
  v_add_u32 v12, s78, v69
  s_lshl_b32 s78, s6, 12
  s_add_u32 s78, s78, 134144
  v_add_u32 v14, s78, v63
  s_lshl_b32 s78, s6, 6
  v_add_u32 v62, s78, v2
  v_lshlrev_b32 v15, 1, v62
  v_add_u32 v15, 134144, v15
  v_lshlrev_b32 v16, 10, v62
  s_lshl_b32 s78, s10, 1
  v_add_u32 v16, s78, v16
  s_lshl_b32 s78, s7, 7
  s_sub_u32 s78, s78, 15
  v_lshl_add_u32 v62, v65, 3, v64
  v_add_u32 v62, s78, v62
  v_lshlrev_b32 v62, 1, v62
  s_mul_i32 s78, s6, 8320
  s_add_u32 s78, s78, 29216
  v_and_b32 v63, 1, v64
  v_cmp_eq_u32 vcc, 1, v63
  v_mov_b32 v63, 4158
  s_nop 0
  v_cndmask_b32 v63, v63, 0, vcc
  v_add3_u32 v17, v62, v63, s78
  v_add_u32 v18, 1024, v17
  v_add_u32 v19, 2048, v17
  v_add_u32 v20, 3072, v17
  v_lshrrev_b32 v62, 8, v0
  v_mul_u32_u24 v62, 9216, v62
  v_and_b32 v63, 255, v0
  v_lshl_add_u32 v3, v63, 4, v62
  v_add_u32 v3, 74752, v3
  v_mov_b32 v24, 1.0
  s_cmp_eq_u32 s8, 0
  s_mov_b32 s78, 0x03020100
  s_cselect_b32 s77, 0x05040c0c, s78
  v_mov_b32 v22, s77
  s_cselect_b32 s77, 0x07060c0c, s78
  v_mov_b32 v23, s77
  s_mov_b32 s78, 0x07060c0c
  s_cselect_b32 s77, 0x05040c0c, s78
  v_mov_b32 v25, s77
  s_cmp_eq_u32 s7, 0
  s_cbranch_scc1 L_KPATH
  v_bfe_u32 v70, v0, 3, 5
  v_and_b32 v71, 7, v0
  v_lshlrev_b32 v31, 8, v70
  v_lshl_add_u32 v31, v71, 4, v31
  v_lshlrev_b32 v1, 6, v71
  v_lshrrev_b32 v72, 2, v64
  v_and_b32 v73, 3, v64
  v_lshlrev_b32 v75, 3, v65
  v_add_u32 v76, 3, v75
  v_sub_u32 v76, v76, v72
  v_lshlrev_b32 v76, 7, v76
  v_lshl_add_u32 v76, v73, 3, v76
  s_lshl_b32 s77, s96, 5
  v_add_u32 v5, s77, v76
  s_lshl_b32 s77, s4, 18
  s_lshl_b32 s78, s96, 16
  s_add_u32 s77, s77, s78
  s_add_u32 s77, s77, 4016
  s_lshl_b32 s78, s5, 7
  s_sub_u32 s77, s77, s78
  v_lshlrev_b32 v6, 12, v64
  v_lshlrev_b32 v76, 1, v75
  v_sub_u32 v6, v6, v76
  v_add_u32 v6, s77, v6
  v_and_b32 v32, 127, v0
  v_bfe_u32 v33, v0, 7, 1
  v_lshlrev_b32 v34, 8, v33
  v_lshl_add_u32 v34, v32, 1, v34
  v_mul_u32_u24 v35, 39168, v33
  v_lshl_add_u32 v35, v32, 2, v35
  v_add_u32 v35, 74752, v35
  s_waitcnt lgkmcnt(0)
  s_barrier
  ds_read_u16_d16_hi v66, v34 offset:26112
  ds_read_u16_d16_hi v67, v34 offset:26624
  ds_read_u16_d16_hi v68, v34 offset:27136
  ds_read_u16_d16_hi v69, v34 offset:27648
  ds_read_u16_d16_hi v70, v34 offset:28160
  ds_read_u16_d16_hi v71, v34 offset:28672
  v_bfe_u32 v75, v0, 7, 1
  v_lshlrev_b32 v75, 4, v75
  v_mov_b32 v72, s76
  v_lshrrev_b32 v72, v75, v72
  v_lshlrev_b32 v72, 16, v72
  v_mul_f32 v72, 0x3fb8aa3b, v72
  v_exp_f32 v72, v72
  s_nop 0
  v_cvt_pk_bf16_f32 v72, 0, v72
  s_waitcnt lgkmcnt(0)
  v_mul_f32 v73, v72, v66
  v_mul_f32 v74, v72, v67
  v_mul_f32 v73, 0x3fb8aa3b, v73
  v_mul_f32 v74, 0.15915494, v74
  v_mul_f32 v68, v72, v68
  v_mul_f32 v69, v72, v69
  v_mul_f32 v76, v70, v68
  v_mul_f32 v77, v70, v69
  v_fma_f32 v76, -v71, v69, v76
  v_fma_f32 v77, v71, v68, v77
  v_mul_f32 v100, 0x40800000, v73
  v_mul_f32 v106, 0x40800000, v74
  v_mul_f32 v101, 0x43000000, v73
  v_mul_f32 v107, 0x43000000, v74
  v_mul_f32 v102, 0x44800000, v73
  v_mul_f32 v108, 0x44800000, v74
  v_exp_f32 v100, v100
  v_fract_f32 v106, v106
  v_exp_f32 v101, v101
  v_fract_f32 v107, v107
  v_exp_f32 v102, v102
  v_fract_f32 v108, v108
  v_cos_f32 v80, v106
  v_sin_f32 v81, v106
  v_cos_f32 v84, v107
  v_sin_f32 v85, v107
  v_cos_f32 v86, v108
  v_sin_f32 v87, v108
  v_mul_f32 v80, v100, v80
  v_mul_f32 v81, v100, v81
  v_mul_f32 v84, v101, v84
  v_mul_f32 v85, v101, v85
  v_mul_f32 v86, v102, v86
  v_mul_f32 v87, v102, v87
  v_pk_mul_f32 v[100:101], v[80:81], v[80:81] op_sel:[0,0] op_sel_hi:[1,0]
  v_pk_fma_f32 v[88:89], v[80:81], v[80:81], v[100:101] op_sel:[1,1,0] op_sel_hi:[0,1,1] neg_lo:[1,0,0]
  v_pk_mul_f32 v[102:103], v[86:87], v[76:77] op_sel:[0,0] op_sel_hi:[1,0]
  v_pk_fma_f32 v[86:87], v[86:87], v[76:77], v[102:103] op_sel:[1,1,0] op_sel_hi:[0,1,1] neg_lo:[1,0,0]
  v_mov_b32 v90, 1.0
  v_mov_b32 v91, 0
  v_mov_b32 v92, v80
  v_mov_b32 v93, v81
  v_cvt_pk_bf16_f32 v112, v90, v91
  ds_write_b32 v35, v112 offset:0
  v_cvt_pk_bf16_f32 v113, v92, v93
  ds_write_b32 v35, v113 offset:544
  v_cvt_pk_bf16_f32 v114, v86, -v87
  ds_write_b32 v35, v114 offset:30464
  v_pk_mul_f32 v[100:101], v[90:91], v[88:89] op_sel:[0,0] op_sel_hi:[1,0]
  v_pk_fma_f32 v[90:91], v[90:91], v[88:89], v[100:101] op_sel:[1,1,0] op_sel_hi:[0,1,1] neg_lo:[1,0,0]
  v_pk_mul_f32 v[104:105], v[92:93], v[88:89] op_sel:[0,0] op_sel_hi:[1,0]
  v_pk_fma_f32 v[92:93], v[92:93], v[88:89], v[104:105] op_sel:[1,1,0] op_sel_hi:[0,1,1] neg_lo:[1,0,0]
  v_pk_mul_f32 v[102:103], v[86:87], v[84:85] op_sel:[0,0] op_sel_hi:[1,0]
  v_pk_fma_f32 v[86:87], v[86:87], v[84:85], v[102:103] op_sel:[1,1,0] op_sel_hi:[0,1,1] neg_lo:[1,0,0]
  v_cvt_pk_bf16_f32 v115, v90, v91
  ds_write_b32 v35, v115 offset:1088
  v_cvt_pk_bf16_f32 v112, v92, v93
  ds_write_b32 v35, v112 offset:1632
  v_cvt_pk_bf16_f32 v113, v86, -v87
  ds_write_b32 v35, v113 offset:31008
  v_pk_mul_f32 v[100:101], v[90:91], v[88:89] op_sel:[0,0] op_sel_hi:[1,0]
  v_pk_fma_f32 v[90:91], v[90:91], v[88:89], v[100:101] op_sel:[1,1,0] op_sel_hi:[0,1,1] neg_lo:[1,0,0]
  v_pk_mul_f32 v[104:105], v[92:93], v[88:89] op_sel:[0,0] op_sel_hi:[1,0]
  v_pk_fma_f32 v[92:93], v[92:93], v[88:89], v[104:105] op_sel:[1,1,0] op_sel_hi:[0,1,1] neg_lo:[1,0,0]
  v_pk_mul_f32 v[102:103], v[86:87], v[84:85] op_sel:[0,0] op_sel_hi:[1,0]
  v_pk_fma_f32 v[86:87], v[86:87], v[84:85], v[102:103] op_sel:[1,1,0] op_sel_hi:[0,1,1] neg_lo:[1,0,0]
  v_cvt_pk_bf16_f32 v114, v90, v91
  ds_write_b32 v35, v114 offset:2176
  v_cvt_pk_bf16_f32 v115, v92, v93
  ds_write_b32 v35, v115 offset:2720
  v_cvt_pk_bf16_f32 v112, v86, -v87
  ds_write_b32 v35, v112 offset:31552
  v_pk_mul_f32 v[100:101], v[90:91], v[88:89] op_sel:[0,0] op_sel_hi:[1,0]
  v_pk_fma_f32 v[90:91], v[90:91], v[88:89], v[100:101] op_sel:[1,1,0] op_sel_hi:[0,1,1] neg_lo:[1,0,0]
  v_pk_mul_f32 v[104:105], v[92:93], v[88:89] op_sel:[0,0] op_sel_hi:[1,0]
  v_pk_fma_f32 v[92:93], v[92:93], v[88:89], v[104:105] op_sel:[1,1,0] op_sel_hi:[0,1,1] neg_lo:[1,0,0]
  v_pk_mul_f32 v[102:103], v[86:87], v[84:85] op_sel:[0,0] op_sel_hi:[1,0]
  v_pk_fma_f32 v[86:87], v[86:87], v[84:85], v[102:103] op_sel:[1,1,0] op_sel_hi:[0,1,1] neg_lo:[1,0,0]
  v_cvt_pk_bf16_f32 v113, v90, v91
  ds_write_b32 v35, v113 offset:3264
  v_cvt_pk_bf16_f32 v114, v92, v93
  ds_write_b32 v35, v114 offset:3808
  v_cvt_pk_bf16_f32 v115, v86, -v87
  ds_write_b32 v35, v115 offset:32096
  v_pk_mul_f32 v[100:101], v[90:91], v[88:89] op_sel:[0,0] op_sel_hi:[1,0]
  v_pk_fma_f32 v[90:91], v[90:91], v[88:89], v[100:101] op_sel:[1,1,0] op_sel_hi:[0,1,1] neg_lo:[1,0,0]
  v_pk_mul_f32 v[104:105], v[92:93], v[88:89] op_sel:[0,0] op_sel_hi:[1,0]
  v_pk_fma_f32 v[92:93], v[92:93], v[88:89], v[104:105] op_sel:[1,1,0] op_sel_hi:[0,1,1] neg_lo:[1,0,0]
  v_pk_mul_f32 v[102:103], v[86:87], v[84:85] op_sel:[0,0] op_sel_hi:[1,0]
  v_pk_fma_f32 v[86:87], v[86:87], v[84:85], v[102:103] op_sel:[1,1,0] op_sel_hi:[0,1,1] neg_lo:[1,0,0]
  v_cvt_pk_bf16_f32 v112, v90, v91
  ds_write_b32 v35, v112 offset:4352
  v_cvt_pk_bf16_f32 v113, v92, v93
  ds_write_b32 v35, v113 offset:4896
  v_cvt_pk_bf16_f32 v114, v86, -v87
  ds_write_b32 v35, v114 offset:32640
  v_pk_mul_f32 v[100:101], v[90:91], v[88:89] op_sel:[0,0] op_sel_hi:[1,0]
  v_pk_fma_f32 v[90:91], v[90:91], v[88:89], v[100:101] op_sel:[1,1,0] op_sel_hi:[0,1,1] neg_lo:[1,0,0]
  v_pk_mul_f32 v[104:105], v[92:93], v[88:89] op_sel:[0,0] op_sel_hi:[1,0]
  v_pk_fma_f32 v[92:93], v[92:93], v[88:89], v[104:105] op_sel:[1,1,0] op_sel_hi:[0,1,1] neg_lo:[1,0,0]
  v_pk_mul_f32 v[102:103], v[86:87], v[84:85] op_sel:[0,0] op_sel_hi:[1,0]
  v_pk_fma_f32 v[86:87], v[86:87], v[84:85], v[102:103] op_sel:[1,1,0] op_sel_hi:[0,1,1] neg_lo:[1,0,0]
  v_cvt_pk_bf16_f32 v115, v90, v91
  ds_write_b32 v35, v115 offset:5440
  v_cvt_pk_bf16_f32 v112, v92, v93
  ds_write_b32 v35, v112 offset:5984
  v_cvt_pk_bf16_f32 v113, v86, -v87
  ds_write_b32 v35, v113 offset:33184
  v_pk_mul_f32 v[100:101], v[90:91], v[88:89] op_sel:[0,0] op_sel_hi:[1,0]
  v_pk_fma_f32 v[90:91], v[90:91], v[88:89], v[100:101] op_sel:[1,1,0] op_sel_hi:[0,1,1] neg_lo:[1,0,0]
  v_pk_mul_f32 v[104:105], v[92:93], v[88:89] op_sel:[0,0] op_sel_hi:[1,0]
  v_pk_fma_f32 v[92:93], v[92:93], v[88:89], v[104:105] op_sel:[1,1,0] op_sel_hi:[0,1,1] neg_lo:[1,0,0]
  v_pk_mul_f32 v[102:103], v[86:87], v[84:85] op_sel:[0,0] op_sel_hi:[1,0]
  v_pk_fma_f32 v[86:87], v[86:87], v[84:85], v[102:103] op_sel:[1,1,0] op_sel_hi:[0,1,1] neg_lo:[1,0,0]
  v_cvt_pk_bf16_f32 v114, v90, v91
  ds_write_b32 v35, v114 offset:6528
  v_cvt_pk_bf16_f32 v115, v92, v93
  ds_write_b32 v35, v115 offset:7072
  v_cvt_pk_bf16_f32 v112, v86, -v87
  ds_write_b32 v35, v112 offset:33728
  v_pk_mul_f32 v[100:101], v[90:91], v[88:89] op_sel:[0,0] op_sel_hi:[1,0]
  v_pk_fma_f32 v[90:91], v[90:91], v[88:89], v[100:101] op_sel:[1,1,0] op_sel_hi:[0,1,1] neg_lo:[1,0,0]
  v_pk_mul_f32 v[104:105], v[92:93], v[88:89] op_sel:[0,0] op_sel_hi:[1,0]
  v_pk_fma_f32 v[92:93], v[92:93], v[88:89], v[104:105] op_sel:[1,1,0] op_sel_hi:[0,1,1] neg_lo:[1,0,0]
  v_pk_mul_f32 v[102:103], v[86:87], v[84:85] op_sel:[0,0] op_sel_hi:[1,0]
  v_pk_fma_f32 v[86:87], v[86:87], v[84:85], v[102:103] op_sel:[1,1,0] op_sel_hi:[0,1,1] neg_lo:[1,0,0]
  v_cvt_pk_bf16_f32 v113, v90, v91
  ds_write_b32 v35, v113 offset:7616
  v_cvt_pk_bf16_f32 v114, v92, v93
  ds_write_b32 v35, v114 offset:8160
  v_cvt_pk_bf16_f32 v115, v86, -v87
  ds_write_b32 v35, v115 offset:34272
  v_pk_mul_f32 v[100:101], v[90:91], v[88:89] op_sel:[0,0] op_sel_hi:[1,0]
  v_pk_fma_f32 v[90:91], v[90:91], v[88:89], v[100:101] op_sel:[1,1,0] op_sel_hi:[0,1,1] neg_lo:[1,0,0]
  v_pk_mul_f32 v[102:103], v[86:87], v[84:85] op_sel:[0,0] op_sel_hi:[1,0]
  v_pk_fma_f32 v[86:87], v[86:87], v[84:85], v[102:103] op_sel:[1,1,0] op_sel_hi:[0,1,1] neg_lo:[1,0,0]
  v_cvt_pk_bf16_f32 v112, v90, v91
  ds_write_b32 v35, v112 offset:8704
  v_cvt_pk_bf16_f32 v113, v86, -v87
  ds_write_b32 v35, v113 offset:34816
  v_pk_mul_f32 v[100:101], v[90:91], v[88:89] op_sel:[0,0] op_sel_hi:[1,0]
  v_pk_fma_f32 v[90:91], v[90:91], v[88:89], v[100:101] op_sel:[1,1,0] op_sel_hi:[0,1,1] neg_lo:[1,0,0]
  v_cvt_pk_bf16_f32 v114, v90, v91
  ds_write_b32 v35, v114 offset:9248
  v_pk_mul_f32 v[100:101], v[90:91], v[88:89] op_sel:[0,0] op_sel_hi:[1,0]
  v_pk_fma_f32 v[90:91], v[90:91], v[88:89], v[100:101] op_sel:[1,1,0] op_sel_hi:[0,1,1] neg_lo:[1,0,0]
  v_cvt_pk_bf16_f32 v115, v90, v91
  ds_write_b32 v35, v115 offset:9792
  v_pk_mul_f32 v[100:101], v[90:91], v[88:89] op_sel:[0,0] op_sel_hi:[1,0]
  v_pk_fma_f32 v[90:91], v[90:91], v[88:89], v[100:101] op_sel:[1,1,0] op_sel_hi:[0,1,1] neg_lo:[1,0,0]
  v_cvt_pk_bf16_f32 v112, v90, v91
  ds_write_b32 v35, v112 offset:10336
  v_pk_mul_f32 v[100:101], v[90:91], v[88:89] op_sel:[0,0] op_sel_hi:[1,0]
  v_pk_fma_f32 v[90:91], v[90:91], v[88:89], v[100:101] op_sel:[1,1,0] op_sel_hi:[0,1,1] neg_lo:[1,0,0]
  v_cvt_pk_bf16_f32 v113, v90, v91
  ds_write_b32 v35, v113 offset:10880
  v_pk_mul_f32 v[100:101], v[90:91], v[88:89] op_sel:[0,0] op_sel_hi:[1,0]
  v_pk_fma_f32 v[90:91], v[90:91], v[88:89], v[100:101] op_sel:[1,1,0] op_sel_hi:[0,1,1] neg_lo:[1,0,0]
  v_cvt_pk_bf16_f32 v114, v90, v91
  ds_write_b32 v35, v114 offset:11424
  v_pk_mul_f32 v[100:101], v[90:91], v[88:89] op_sel:[0,0] op_sel_hi:[1,0]
  v_pk_fma_f32 v[90:91], v[90:91], v[88:89], v[100:101] op_sel:[1,1,0] op_sel_hi:[0,1,1] neg_lo:[1,0,0]
  v_cvt_pk_bf16_f32 v115, v90, v91
  ds_write_b32 v35, v115 offset:11968
  v_pk_mul_f32 v[100:101], v[90:91], v[88:89] op_sel:[0,0] op_sel_hi:[1,0]
  v_pk_fma_f32 v[90:91], v[90:91], v[88:89], v[100:101] op_sel:[1,1,0] op_sel_hi:[0,1,1] neg_lo:[1,0,0]
  v_cvt_pk_bf16_f32 v112, v90, v91
  ds_write_b32 v35, v112 offset:12512
  s_waitcnt vmcnt(2) lgkmcnt(0)
  s_barrier
  s_cmp_eq_u32 s3, 6
  s_cbranch_scc0 L_NOPT
  s_lshl_b32 s77, s4, 18
  s_add_u32 s77, s77, 3968
  s_lshl_b32 s78, s5, 7
  s_sub_u32 s77, s77, s78
  v_lshlrev_b32 v116, 12, v2
  v_add_u32 v116, s77, v116
  s_mov_b32 s78, 2097152
  buffer_load_dword v30, v116, s[60:63], 0 offen sc1
  buffer_load_dword v30, v116, s[60:63], s78 offen sc1
L_NOPT:
  ds_read_b128 v[32:35], v31 offset:640
  ds_read_b128 v[36:39], v31 offset:768
  ds_read_b128 v[40:43], v31 offset:896
  ds_read_b128 v[44:47], v31 offset:1024
  ds_read_b128 v[48:51], v31 offset:1152
  ds_read_b128 v[52:55], v1 offset:25600
  ds_read_b128 v[56:59], v1 offset:25616
  ds_read_b128 v[60:63], v1 offset:25632
  ds_read_b128 v[64:67], v1 offset:25648
  s_cmp_eq_u32 s8, 0
  s_cselect_b32 s77, s100, s101
  s_lshl_b32 s78, s9, 4
  s_lshr_b32 s77, s77, s78
  s_lshl_b32 s77, s77, 16
  v_mov_b32 v26, s77
  s_waitcnt lgkmcnt(0)
  v_and_b32 v68, v28, v52
  v_lshlrev_b32 v69, 16, v54
  v_and_b32 v70, v28, v56
  v_lshlrev_b32 v71, 16, v58
  v_and_b32 v72, v28, v60
  v_lshlrev_b32 v73, 16, v62
  v_and_b32 v74, v28, v64
  v_lshlrev_b32 v75, 16, v66
  v_lshrrev_b32 v76, 16, v52
  v_and_b32 v77, v27, v54
  v_lshrrev_b32 v78, 16, v56
  v_and_b32 v79, v27, v58
  v_lshrrev_b32 v80, 16, v60
  v_and_b32 v81, v27, v62
  v_lshrrev_b32 v82, 16, v64
  v_and_b32 v83, v27, v66
  v_and_b32 v84, v28, v53
  v_lshlrev_b32 v85, 16, v55
  v_and_b32 v86, v28, v57
  v_lshlrev_b32 v87, 16, v59
  v_and_b32 v88, v28, v61
  v_lshlrev_b32 v89, 16, v63
  v_and_b32 v90, v28, v65
  v_lshlrev_b32 v91, 16, v67
  v_lshrrev_b32 v92, 16, v53
  v_and_b32 v93, v27, v55
  v_lshrrev_b32 v94, 16, v57
  v_and_b32 v95, v27, v59
  v_lshrrev_b32 v96, 16, v61
  v_and_b32 v97, v27, v63
  v_lshrrev_b32 v98, 16, v65
  v_and_b32 v99, v27, v67
  v_dot2_f32_bf16 v100, v32, v92, 0
  v_dot2_f32_bf16 v101, v32, v93, 0
  v_dot2_f32_bf16 v102, v33, v94, 0
  v_dot2_f32_bf16 v103, v33, v95, 0
  v_dot2_f32_bf16 v104, v34, v96, 0
  v_dot2_f32_bf16 v105, v34, v97, 0
  v_dot2_f32_bf16 v106, v35, v98, 0
  v_dot2_f32_bf16 v107, v35, v99, 0
  v_dot2_f32_bf16 v108, v36, v84, 0
  v_dot2_f32_bf16 v109, v36, v85, 0
  v_dot2_f32_bf16 v110, v37, v86, 0
  v_dot2_f32_bf16 v111, v37, v87, 0
  v_dot2_f32_bf16 v112, v38, v88, 0
  v_dot2_f32_bf16 v113, v38, v89, 0
  v_dot2_f32_bf16 v114, v39, v90, 0
  v_dot2_f32_bf16 v115, v39, v91, 0
  v_cvt_pk_bf16_f32 v52, v100, v108
  v_cvt_pk_bf16_f32 v53, v101, v109
  v_cvt_pk_bf16_f32 v54, v102, v110
  v_cvt_pk_bf16_f32 v55, v103, v111
  v_cvt_pk_bf16_f32 v56, v104, v112
  v_cvt_pk_bf16_f32 v57, v105, v113
  v_cvt_pk_bf16_f32 v58, v106, v114
  v_cvt_pk_bf16_f32 v59, v107, v115
  v_dot2_f32_bf16 v100, v52, v21, 0
  v_dot2_f32_bf16 v101, v53, v21, 0
  v_dot2_f32_bf16 v102, v54, v21, 0
  v_dot2_f32_bf16 v103, v55, v21, 0
  v_dot2_f32_bf16 v104, v56, v21, 0
  v_dot2_f32_bf16 v105, v57, v21, 0
  v_dot2_f32_bf16 v106, v58, v21, 0
  v_dot2_f32_bf16 v107, v59, v21, 0
  v_dot2_f32_bf16 v108, v40, v76, 0
  v_dot2_f32_bf16 v109, v40, v77, 0
  v_dot2_f32_bf16 v110, v41, v78, 0
  v_dot2_f32_bf16 v111, v41, v79, 0
  v_dot2_f32_bf16 v112, v42, v80, 0
  v_dot2_f32_bf16 v113, v42, v81, 0
  v_dot2_f32_bf16 v114, v43, v82, 0
  v_dot2_f32_bf16 v115, v43, v83, 0
  v_cvt_pk_bf16_f32 v52, v100, v108
  v_cvt_pk_bf16_f32 v53, v101, v109
  v_cvt_pk_bf16_f32 v54, v102, v110
  v_cvt_pk_bf16_f32 v55, v103, v111
  v_cvt_pk_bf16_f32 v56, v104, v112
  v_cvt_pk_bf16_f32 v57, v105, v113
  v_cvt_pk_bf16_f32 v58, v106, v114
  v_cvt_pk_bf16_f32 v59, v107, v115
  v_dot2_f32_bf16 v100, v52, v21, 0
  v_dot2_f32_bf16 v101, v53, v21, 0
  v_dot2_f32_bf16 v102, v54, v21, 0
  v_dot2_f32_bf16 v103, v55, v21, 0
  v_dot2_f32_bf16 v104, v56, v21, 0
  v_dot2_f32_bf16 v105, v57, v21, 0
  v_dot2_f32_bf16 v106, v58, v21, 0
  v_dot2_f32_bf16 v107, v59, v21, 0
  v_dot2_f32_bf16 v108, v44, v68, 0
  v_dot2_f32_bf16 v109, v44, v69, 0
  v_dot2_f32_bf16 v110, v45, v70, 0
  v_dot2_f32_bf16 v111, v45, v71, 0
  v_dot2_f32_bf16 v112, v46, v72, 0
  v_dot2_f32_bf16 v113, v46, v73, 0
  v_dot2_f32_bf16 v114, v47, v74, 0
  v_dot2_f32_bf16 v115, v47, v75, 0
  v_cvt_pk_bf16_f32 v52, v100, v108
  v_cvt_pk_bf16_f32 v53, v101, v109
  v_cvt_pk_bf16_f32 v54, v102, v110
  v_cvt_pk_bf16_f32 v55, v103, v111
  v_cvt_pk_bf16_f32 v56, v104, v112
  v_cvt_pk_bf16_f32 v57, v105, v113
  v_cvt_pk_bf16_f32 v58, v106, v114
  v_cvt_pk_bf16_f32 v59, v107, v115
  v_dot2_f32_bf16 v100, v52, v21, 0
  v_dot2_f32_bf16 v101, v53, v21, 0
  v_dot2_f32_bf16 v102, v54, v21, 0
  v_dot2_f32_bf16 v103, v55, v21, 0
  v_dot2_f32_bf16 v104, v56, v21, 0
  v_dot2_f32_bf16 v105, v57, v21, 0
  v_dot2_f32_bf16 v106, v58, v21, 0
  v_dot2_f32_bf16 v107, v59, v21, 0
  v_and_b32 v52, v28, v120
  v_and_b32 v53, v27, v120
  v_and_b32 v54, v28, v121
  v_and_b32 v55, v27, v121
  v_and_b32 v56, v28, v122
  v_and_b32 v57, v27, v122
  v_and_b32 v58, v28, v123
  v_and_b32 v59, v27, v123
  v_cvt_pk_bf16_f32 v108, v100, v101
  v_cvt_pk_bf16_f32 v109, v102, v103
  v_cvt_pk_bf16_f32 v110, v104, v105
  v_cvt_pk_bf16_f32 v111, v106, v107
  v_dot2_f32_bf16 v100, v108, v52, 0
  v_dot2_f32_bf16 v101, v108, v53, 0
  v_dot2_f32_bf16 v102, v109, v54, 0
  v_dot2_f32_bf16 v103, v109, v55, 0
  v_dot2_f32_bf16 v104, v110, v56, 0
  v_dot2_f32_bf16 v105, v110, v57, 0
  v_dot2_f32_bf16 v106, v111, v58, 0
  v_dot2_f32_bf16 v107, v111, v59, 0
  v_cvt_pk_bf16_f32 v116, v100, v101
  v_cvt_pk_bf16_f32 v117, v102, v103
  v_cvt_pk_bf16_f32 v118, v104, v105
  v_cvt_pk_bf16_f32 v119, v106, v107
  ds_write_b128 v31, v[116:119] offset:17408
  v_dot2_f32_bf16 v100, v36, v92, 0
  v_dot2_f32_bf16 v101, v36, v93, 0
  v_dot2_f32_bf16 v102, v37, v94, 0
  v_dot2_f32_bf16 v103, v37, v95, 0
  v_dot2_f32_bf16 v104, v38, v96, 0
  v_dot2_f32_bf16 v105, v38, v97, 0
  v_dot2_f32_bf16 v106, v39, v98, 0
  v_dot2_f32_bf16 v107, v39, v99, 0
  v_dot2_f32_bf16 v108, v40, v84, 0
  v_dot2_f32_bf16 v109, v40, v85, 0
  v_dot2_f32_bf16 v110, v41, v86, 0
  v_dot2_f32_bf16 v111, v41, v87, 0
  v_dot2_f32_bf16 v112, v42, v88, 0
  v_dot2_f32_bf16 v113, v42, v89, 0
  v_dot2_f32_bf16 v114, v43, v90, 0
  v_dot2_f32_bf16 v115, v43, v91, 0
  v_cvt_pk_bf16_f32 v52, v100, v108
  v_cvt_pk_bf16_f32 v53, v101, v109
  v_cvt_pk_bf16_f32 v54, v102, v110
  v_cvt_pk_bf16_f32 v55, v103, v111
  v_cvt_pk_bf16_f32 v56, v104, v112
  v_cvt_pk_bf16_f32 v57, v105, v113
  v_cvt_pk_bf16_f32 v58, v106, v114
  v_cvt_pk_bf16_f32 v59, v107, v115
  v_dot2_f32_bf16 v100, v52, v21, 0
  v_dot2_f32_bf16 v101, v53, v21, 0
  v_dot2_f32_bf16 v102, v54, v21, 0
  v_dot2_f32_bf16 v103, v55, v21, 0
  v_dot2_f32_bf16 v104, v56, v21, 0
  v_dot2_f32_bf16 v105, v57, v21, 0
  v_dot2_f32_bf16 v106, v58, v21, 0
  v_dot2_f32_bf16 v107, v59, v21, 0
  v_dot2_f32_bf16 v108, v44, v76, 0
  v_dot2_f32_bf16 v109, v44, v77, 0
  v_dot2_f32_bf16 v110, v45, v78, 0
  v_dot2_f32_bf16 v111, v45, v79, 0
  v_dot2_f32_bf16 v112, v46, v80, 0
  v_dot2_f32_bf16 v113, v46, v81, 0
  v_dot2_f32_bf16 v114, v47, v82, 0
  v_dot2_f32_bf16 v115, v47, v83, 0
  v_cvt_pk_bf16_f32 v52, v100, v108
  v_cvt_pk_bf16_f32 v53, v101, v109
  v_cvt_pk_bf16_f32 v54, v102, v110
  v_cvt_pk_bf16_f32 v55, v103, v111
  v_cvt_pk_bf16_f32 v56, v104, v112
  v_cvt_pk_bf16_f32 v57, v105, v113
  v_cvt_pk_bf16_f32 v58, v106, v114
  v_cvt_pk_bf16_f32 v59, v107, v115
  v_dot2_f32_bf16 v100, v52, v21, 0
  v_dot2_f32_bf16 v101, v53, v21, 0
  v_dot2_f32_bf16 v102, v54, v21, 0
  v_dot2_f32_bf16 v103, v55, v21, 0
  v_dot2_f32_bf16 v104, v56, v21, 0
  v_dot2_f32_bf16 v105, v57, v21, 0
  v_dot2_f32_bf16 v106, v58, v21, 0
  v_dot2_f32_bf16 v107, v59, v21, 0
  v_dot2_f32_bf16 v108, v48, v68, 0
  v_dot2_f32_bf16 v109, v48, v69, 0
  v_dot2_f32_bf16 v110, v49, v70, 0
  v_dot2_f32_bf16 v111, v49, v71, 0
  v_dot2_f32_bf16 v112, v50, v72, 0
  v_dot2_f32_bf16 v113, v50, v73, 0
  v_dot2_f32_bf16 v114, v51, v74, 0
  v_dot2_f32_bf16 v115, v51, v75, 0
  v_cvt_pk_bf16_f32 v52, v100, v108
  v_cvt_pk_bf16_f32 v53, v101, v109
  v_cvt_pk_bf16_f32 v54, v102, v110
  v_cvt_pk_bf16_f32 v55, v103, v111
  v_cvt_pk_bf16_f32 v56, v104, v112
  v_cvt_pk_bf16_f32 v57, v105, v113
  v_cvt_pk_bf16_f32 v58, v106, v114
  v_cvt_pk_bf16_f32 v59, v107, v115
  v_dot2_f32_bf16 v100, v52, v21, 0
  v_dot2_f32_bf16 v101, v53, v21, 0
  v_dot2_f32_bf16 v102, v54, v21, 0
  v_dot2_f32_bf16 v103, v55, v21, 0
  v_dot2_f32_bf16 v104, v56, v21, 0
  v_dot2_f32_bf16 v105, v57, v21, 0
  v_dot2_f32_bf16 v106, v58, v21, 0
  v_dot2_f32_bf16 v107, v59, v21, 0
  v_and_b32 v52, v28, v124
  v_and_b32 v53, v27, v124
  v_and_b32 v54, v28, v125
  v_and_b32 v55, v27, v125
  v_and_b32 v56, v28, v126
  v_and_b32 v57, v27, v126
  v_and_b32 v58, v28, v127
  v_and_b32 v59, v27, v127
  v_cvt_pk_bf16_f32 v108, v100, v101
  v_cvt_pk_bf16_f32 v109, v102, v103
  v_cvt_pk_bf16_f32 v110, v104, v105
  v_cvt_pk_bf16_f32 v111, v106, v107
  v_dot2_f32_bf16 v100, v108, v52, 0
  v_dot2_f32_bf16 v101, v108, v53, 0
  v_dot2_f32_bf16 v102, v109, v54, 0
  v_dot2_f32_bf16 v103, v109, v55, 0
  v_dot2_f32_bf16 v104, v110, v56, 0
  v_dot2_f32_bf16 v105, v110, v57, 0
  v_dot2_f32_bf16 v106, v111, v58, 0
  v_dot2_f32_bf16 v107, v111, v59, 0
  v_cvt_pk_bf16_f32 v116, v100, v101
  v_cvt_pk_bf16_f32 v117, v102, v103
  v_cvt_pk_bf16_f32 v118, v104, v105
  v_cvt_pk_bf16_f32 v119, v106, v107
  ds_write_b128 v31, v[116:119] offset:17536
  s_cmp_eq_u32 s3, 6
  s_cbranch_scc0 L_XW1
  s_waitcnt vmcnt(2) lgkmcnt(0)
  s_branch L_XW2
L_XW1:
  s_waitcnt vmcnt(0) lgkmcnt(0)
L_XW2:
  s_barrier
  ds_read_b64_tr_b16 v[32:33], v5 offset:17920
  ds_read_b64_tr_b16 v[34:35], v5 offset:17408
  ds_read_b64_tr_b16 v[36:37], v5 offset:22016
  ds_read_b64_tr_b16 v[38:39], v5 offset:21504
  ds_read_b64_tr_b16 v[40:41], v5 offset:9728
  ds_read_b64_tr_b16 v[42:43], v5 offset:9216
  ds_read_b64_tr_b16 v[44:45], v5 offset:13824
  ds_read_b64_tr_b16 v[46:47], v5 offset:13312
  s_mov_b32 s77, 2097152
  s_mov_b32 s78, 0
  s_waitcnt lgkmcnt(6)
  buffer_store_dwordx4 v[32:35], v6, s[60:63], s77 offen offset:64
  s_waitcnt lgkmcnt(4)
  buffer_store_dwordx4 v[36:39], v6, s[60:63], s77 offen offset:0
  s_waitcnt lgkmcnt(2)
  buffer_store_dwordx4 v[40:43], v6, s[60:63], s78 offen offset:64
  s_waitcnt lgkmcnt(0)
  buffer_store_dwordx4 v[44:47], v6, s[60:63], s78 offen offset:0
  v_mov_b32 v101, 26176
  ds_read_b32 v120, v101
  s_lshl_b32 s77, s4, 5
  s_add_u32 s77, s77, s5
  s_lshl_b32 s77, s77, 3
  s_add_u32 s78, s77, 8585216
  v_mov_b32 v124, s78
  s_waitcnt lgkmcnt(0)
  v_xor_b32 v121, 0x5a5a5a5a, v120
  v_add_u32 v121, s97, v121
  s_cmp_eq_u32 s8, 0
  s_cbranch_scc0 L_XNOAL
  ds_read2_b32 a[0:1], v17 offset0:0 offset1:1
  ds_read2_b32 a[2:3], v17 offset0:2 offset1:3
  ds_read2_b32 a[4:5], v17 offset0:16 offset1:17
  ds_read2_b32 a[6:7], v17 offset0:18 offset1:19
  ds_read2_b32 a[8:9], v17 offset0:32 offset1:33
  ds_read2_b32 a[10:11], v17 offset0:34 offset1:35
  ds_read2_b32 a[12:13], v17 offset0:48 offset1:49
  ds_read2_b32 a[14:15], v17 offset0:50 offset1:51
  ds_read2_b32 a[16:17], v17 offset0:128 offset1:129
  ds_read2_b32 a[18:19], v17 offset0:130 offset1:131
  ds_read2_b32 a[20:21], v17 offset0:144 offset1:145
  ds_read2_b32 a[22:23], v17 offset0:146 offset1:147
  ds_read2_b32 a[24:25], v17 offset0:160 offset1:161
  ds_read2_b32 a[26:27], v17 offset0:162 offset1:163
  ds_read2_b32 a[28:29], v17 offset0:176 offset1:177
  ds_read2_b32 a[30:31], v17 offset0:178 offset1:179
  ds_read2_b32 a[32:33], v18 offset0:0 offset1:1
  ds_read2_b32 a[34:35], v18 offset0:2 offset1:3
  ds_read2_b32 a[36:37], v18 offset0:16 offset1:17
  ds_read2_b32 a[38:39], v18 offset0:18 offset1:19
  ds_read2_b32 a[40:41], v18 offset0:32 offset1:33
  ds_read2_b32 a[42:43], v18 offset0:34 offset1:35
  ds_read2_b32 a[44:45], v18 offset0:48 offset1:49
  ds_read2_b32 a[46:47], v18 offset0:50 offset1:51
  ds_read2_b32 a[48:49], v18 offset0:128 offset1:129
  ds_read2_b32 a[50:51], v18 offset0:130 offset1:131
  ds_read2_b32 a[52:53], v18 offset0:144 offset1:145
  ds_read2_b32 a[54:55], v18 offset0:146 offset1:147
  ds_read2_b32 a[56:57], v18 offset0:160 offset1:161
  ds_read2_b32 a[58:59], v18 offset0:162 offset1:163
  ds_read2_b32 a[60:61], v18 offset0:176 offset1:177
  ds_read2_b32 a[62:63], v18 offset0:178 offset1:179
  ds_read2_b32 a[64:65], v19 offset0:0 offset1:1
  ds_read2_b32 a[66:67], v19 offset0:2 offset1:3
  ds_read2_b32 a[68:69], v19 offset0:16 offset1:17
  ds_read2_b32 a[70:71], v19 offset0:18 offset1:19
  ds_read2_b32 a[72:73], v19 offset0:32 offset1:33
  ds_read2_b32 a[74:75], v19 offset0:34 offset1:35
  ds_read2_b32 a[76:77], v19 offset0:48 offset1:49
  ds_read2_b32 a[78:79], v19 offset0:50 offset1:51
  ds_read2_b32 a[80:81], v19 offset0:128 offset1:129
  ds_read2_b32 a[82:83], v19 offset0:130 offset1:131
  ds_read2_b32 a[84:85], v19 offset0:144 offset1:145
  ds_read2_b32 a[86:87], v19 offset0:146 offset1:147
  ds_read2_b32 a[88:89], v19 offset0:160 offset1:161
  ds_read2_b32 a[90:91], v19 offset0:162 offset1:163
  ds_read2_b32 a[92:93], v19 offset0:176 offset1:177
  ds_read2_b32 a[94:95], v19 offset0:178 offset1:179
  ds_read2_b32 a[96:97], v20 offset0:0 offset1:1
  ds_read2_b32 a[98:99], v20 offset0:2 offset1:3
  ds_read2_b32 a[100:101], v20 offset0:16 offset1:17
  ds_read2_b32 a[102:103], v20 offset0:18 offset1:19
  ds_read2_b32 a[104:105], v20 offset0:32 offset1:33
  ds_read2_b32 a[106:107], v20 offset0:34 offset1:35
  ds_read2_b32 a[108:109], v20 offset0:48 offset1:49
  ds_read2_b32 a[110:111], v20 offset0:50 offset1:51
  ds_read2_b32 a[112:113], v20 offset0:128 offset1:129
  ds_read2_b32 a[114:115], v20 offset0:130 offset1:131
  ds_read2_b32 a[116:117], v20 offset0:144 offset1:145
  ds_read2_b32 a[118:119], v20 offset0:146 offset1:147
  ds_read2_b32 a[120:121], v20 offset0:160 offset1:161
  ds_read2_b32 a[122:123], v20 offset0:162 offset1:163
  ds_read2_b32 a[124:125], v20 offset0:176 offset1:177
  ds_read2_b32 a[126:127], v20 offset0:178 offset1:179
L_XNOAL:
  s_waitcnt vmcnt(0)
  s_barrier
  s_cmp_eq_u32 s3, 7
  s_cbranch_scc0 L_JOIN
  s_mov_b64 exec, 1
  buffer_store_dwordx2 v[120:121], v124, s[60:63], 0 offen
  s_mov_b64 exec, -1
  s_branch L_JOIN
L_KPATH:
  v_mov_b32 v5, 0
  v_mov_b32 v6, -1
  v_and_b32 v32, 127, v0
  v_bfe_u32 v33, v0, 7, 1
  v_lshlrev_b32 v34, 8, v33
  v_lshl_add_u32 v34, v32, 1, v34
  v_mul_u32_u24 v35, 39168, v33
  v_lshl_add_u32 v35, v32, 2, v35
  v_add_u32 v35, 74752, v35
  v_and_b32 v45, 255, v0
  v_lshlrev_b32 v45, 3, v45
  v_add_u32 v46, 0, v45
  v_add_u32 v47, 1, v45
  v_cvt_f32_u32 v46, v46
  v_cvt_f32_u32 v47, v47
  v_cvt_pk_bf16_f32 v46, v46, v47
  v_and_b32 v47, v27, v46
  v_lshlrev_b32 v46, 16, v46
  v_cvt_u32_f32 v46, v46
  v_lshlrev_b32 v36, 1, v46
  v_add_u32 v36, 62464, v36
  v_cvt_u32_f32 v47, v47
  v_lshlrev_b32 v37, 1, v47
  v_add_u32 v37, 62464, v37
  v_add_u32 v46, 2, v45
  v_add_u32 v47, 3, v45
  v_cvt_f32_u32 v46, v46
  v_cvt_f32_u32 v47, v47
  v_cvt_pk_bf16_f32 v46, v46, v47
  v_and_b32 v47, v27, v46
  v_lshlrev_b32 v46, 16, v46
  v_cvt_u32_f32 v46, v46
  v_lshlrev_b32 v38, 1, v46
  v_add_u32 v38, 62464, v38
  v_cvt_u32_f32 v47, v47
  v_lshlrev_b32 v39, 1, v47
  v_add_u32 v39, 62464, v39
  v_add_u32 v46, 4, v45
  v_add_u32 v47, 5, v45
  v_cvt_f32_u32 v46, v46
  v_cvt_f32_u32 v47, v47
  v_cvt_pk_bf16_f32 v46, v46, v47
  v_and_b32 v47, v27, v46
  v_lshlrev_b32 v46, 16, v46
  v_cvt_u32_f32 v46, v46
  v_lshlrev_b32 v40, 1, v46
  v_add_u32 v40, 62464, v40
  v_cvt_u32_f32 v47, v47
  v_lshlrev_b32 v41, 1, v47
  v_add_u32 v41, 62464, v41
  v_add_u32 v46, 6, v45
  v_add_u32 v47, 7, v45
  v_cvt_f32_u32 v46, v46
  v_cvt_f32_u32 v47, v47
  v_cvt_pk_bf16_f32 v46, v46, v47
  v_and_b32 v47, v27, v46
  v_lshlrev_b32 v46, 16, v46
  v_cvt_u32_f32 v46, v46
  v_lshlrev_b32 v42, 1, v46
  v_add_u32 v42, 62464, v42
  v_cvt_u32_f32 v47, v47
  v_lshlrev_b32 v43, 1, v47
  v_add_u32 v43, 62464, v43
  v_add_u32 v46, 8, v45
  v_add_u32 v47, 9, v45
  v_cvt_f32_u32 v46, v46
  v_cvt_f32_u32 v47, v47
  v_cvt_pk_bf16_f32 v46, v46, v47
  v_and_b32 v47, v27, v46
  v_lshlrev_b32 v46, 16, v46
  v_cvt_u32_f32 v46, v46
  v_lshlrev_b32 v44, 1, v46
  v_add_u32 v44, 62464, v44
  v_lshlrev_b32 v31, 1, v45
  v_add_u32 v31, 29216, v31
  v_lshlrev_b32 v46, 1, v45
  v_add_u32 v46, s13, v46
  s_cmp_eq_u32 s3, 3
  s_cbranch_scc0 L_KW1
  s_waitcnt vmcnt(4) lgkmcnt(0)
  s_branch L_KW2
L_KW1:
  s_waitcnt vmcnt(3) lgkmcnt(0)
L_KW2:
  s_barrier
  buffer_load_dwordx4 v[48:51], v46, s[68:71], 0 offen
  buffer_load_dwordx4 v[52:55], v46, s[68:71], 0 offen offset:4
  s_mov_b32 s77, 4096
  buffer_load_dwordx4 v[56:59], v46, s[68:71], s77 offen
  buffer_load_dwordx4 v[60:63], v46, s[68:71], s77 offen offset:4
  ds_read_u16_d16_hi v66, v34 offset:26112
  ds_read_u16_d16_hi v67, v34 offset:26624
  ds_read_u16_d16_hi v68, v34 offset:27136
  ds_read_u16_d16_hi v69, v34 offset:27648
  ds_read_u16_d16_hi v70, v34 offset:28160
  ds_read_u16_d16_hi v71, v34 offset:28672
  v_bfe_u32 v75, v0, 7, 1
  v_lshlrev_b32 v75, 4, v75
  v_mov_b32 v72, s76
  v_lshrrev_b32 v72, v75, v72
  v_lshlrev_b32 v72, 16, v72
  v_mul_f32 v72, 0x3fb8aa3b, v72
  v_exp_f32 v72, v72
  s_nop 0
  v_cvt_pk_bf16_f32 v72, 0, v72
  s_waitcnt lgkmcnt(0)
  v_mul_f32 v73, v72, v66
  v_mul_f32 v74, v72, v67
  v_mul_f32 v73, 0x3fb8aa3b, v73
  v_mul_f32 v74, 0.15915494, v74
  v_mul_f32 v68, v72, v68
  v_mul_f32 v69, v72, v69
  v_mul_f32 v76, v70, v68
  v_mul_f32 v77, v70, v69
  v_fma_f32 v76, -v71, v69, v76
  v_fma_f32 v77, v71, v68, v77
  v_mul_f32 v112, 0x3f800000, v73
  v_mul_f32 v118, 0x3f800000, v74
  v_mul_f32 v113, 0x42800000, v73
  v_mul_f32 v119, 0x42800000, v74
  v_exp_f32 v112, v112
  v_fract_f32 v118, v118
  v_exp_f32 v113, v113
  v_fract_f32 v119, v119
  v_cos_f32 v78, v118
  v_sin_f32 v79, v118
  v_cos_f32 v82, v119
  v_sin_f32 v83, v119
  v_mul_f32 v78, v112, v78
  v_mul_f32 v79, v112, v79
  v_mul_f32 v82, v113, v82
  v_mul_f32 v83, v113, v83
  v_mov_b32 v92, v76
  v_mov_b32 v93, v77
  v_pk_mul_f32 v[116:117], v[92:93], v[78:79] op_sel:[0,0] op_sel_hi:[1,0]
  v_pk_fma_f32 v[94:95], v[92:93], v[78:79], v[116:117] op_sel:[1,1,0] op_sel_hi:[0,1,1] neg_lo:[1,0,0]
  v_pk_mul_f32 v[116:117], v[94:95], v[78:79] op_sel:[0,0] op_sel_hi:[1,0]
  v_pk_fma_f32 v[96:97], v[94:95], v[78:79], v[116:117] op_sel:[1,1,0] op_sel_hi:[0,1,1] neg_lo:[1,0,0]
  v_pk_mul_f32 v[116:117], v[96:97], v[78:79] op_sel:[0,0] op_sel_hi:[1,0]
  v_pk_fma_f32 v[98:99], v[96:97], v[78:79], v[116:117] op_sel:[1,1,0] op_sel_hi:[0,1,1] neg_lo:[1,0,0]
  v_cvt_pk_bf16_f32 v124, v92, -v93
  ds_write_b32 v35, v124 offset:13056
  v_cvt_pk_bf16_f32 v125, v94, -v95
  ds_write_b32 v35, v125 offset:13600
  v_cvt_pk_bf16_f32 v126, v96, -v97
  ds_write_b32 v35, v126 offset:14144
  v_cvt_pk_bf16_f32 v127, v98, -v99
  ds_write_b32 v35, v127 offset:14688
  v_pk_mul_f32 v[116:117], v[92:93], v[82:83] op_sel:[0,0] op_sel_hi:[1,0]
  v_pk_fma_f32 v[92:93], v[92:93], v[82:83], v[116:117] op_sel:[1,1,0] op_sel_hi:[0,1,1] neg_lo:[1,0,0]
  v_pk_mul_f32 v[118:119], v[94:95], v[82:83] op_sel:[0,0] op_sel_hi:[1,0]
  v_pk_fma_f32 v[94:95], v[94:95], v[82:83], v[118:119] op_sel:[1,1,0] op_sel_hi:[0,1,1] neg_lo:[1,0,0]
  v_pk_mul_f32 v[120:121], v[96:97], v[82:83] op_sel:[0,0] op_sel_hi:[1,0]
  v_pk_fma_f32 v[96:97], v[96:97], v[82:83], v[120:121] op_sel:[1,1,0] op_sel_hi:[0,1,1] neg_lo:[1,0,0]
  v_pk_mul_f32 v[122:123], v[98:99], v[82:83] op_sel:[0,0] op_sel_hi:[1,0]
  v_pk_fma_f32 v[98:99], v[98:99], v[82:83], v[122:123] op_sel:[1,1,0] op_sel_hi:[0,1,1] neg_lo:[1,0,0]
  v_cvt_pk_bf16_f32 v124, v92, -v93
  ds_write_b32 v35, v124 offset:15232
  v_cvt_pk_bf16_f32 v125, v94, -v95
  ds_write_b32 v35, v125 offset:15776
  v_cvt_pk_bf16_f32 v126, v96, -v97
  ds_write_b32 v35, v126 offset:16320
  v_cvt_pk_bf16_f32 v127, v98, -v99
  ds_write_b32 v35, v127 offset:16864
  v_pk_mul_f32 v[116:117], v[92:93], v[82:83] op_sel:[0,0] op_sel_hi:[1,0]
  v_pk_fma_f32 v[92:93], v[92:93], v[82:83], v[116:117] op_sel:[1,1,0] op_sel_hi:[0,1,1] neg_lo:[1,0,0]
  v_pk_mul_f32 v[118:119], v[94:95], v[82:83] op_sel:[0,0] op_sel_hi:[1,0]
  v_pk_fma_f32 v[94:95], v[94:95], v[82:83], v[118:119] op_sel:[1,1,0] op_sel_hi:[0,1,1] neg_lo:[1,0,0]
  v_pk_mul_f32 v[120:121], v[96:97], v[82:83] op_sel:[0,0] op_sel_hi:[1,0]
  v_pk_fma_f32 v[96:97], v[96:97], v[82:83], v[120:121] op_sel:[1,1,0] op_sel_hi:[0,1,1] neg_lo:[1,0,0]
  v_pk_mul_f32 v[122:123], v[98:99], v[82:83] op_sel:[0,0] op_sel_hi:[1,0]
  v_pk_fma_f32 v[98:99], v[98:99], v[82:83], v[122:123] op_sel:[1,1,0] op_sel_hi:[0,1,1] neg_lo:[1,0,0]
  v_cvt_pk_bf16_f32 v124, v92, -v93
  ds_write_b32 v35, v124 offset:17408
  v_cvt_pk_bf16_f32 v125, v94, -v95
  ds_write_b32 v35, v125 offset:17952
  v_cvt_pk_bf16_f32 v126, v96, -v97
  ds_write_b32 v35, v126 offset:18496
  v_cvt_pk_bf16_f32 v127, v98, -v99
  ds_write_b32 v35, v127 offset:19040
  v_pk_mul_f32 v[116:117], v[92:93], v[82:83] op_sel:[0,0] op_sel_hi:[1,0]
  v_pk_fma_f32 v[92:93], v[92:93], v[82:83], v[116:117] op_sel:[1,1,0] op_sel_hi:[0,1,1] neg_lo:[1,0,0]
  v_pk_mul_f32 v[118:119], v[94:95], v[82:83] op_sel:[0,0] op_sel_hi:[1,0]
  v_pk_fma_f32 v[94:95], v[94:95], v[82:83], v[118:119] op_sel:[1,1,0] op_sel_hi:[0,1,1] neg_lo:[1,0,0]
  v_pk_mul_f32 v[120:121], v[96:97], v[82:83] op_sel:[0,0] op_sel_hi:[1,0]
  v_pk_fma_f32 v[96:97], v[96:97], v[82:83], v[120:121] op_sel:[1,1,0] op_sel_hi:[0,1,1] neg_lo:[1,0,0]
  v_pk_mul_f32 v[122:123], v[98:99], v[82:83] op_sel:[0,0] op_sel_hi:[1,0]
  v_pk_fma_f32 v[98:99], v[98:99], v[82:83], v[122:123] op_sel:[1,1,0] op_sel_hi:[0,1,1] neg_lo:[1,0,0]
  v_cvt_pk_bf16_f32 v124, v92, -v93
  ds_write_b32 v35, v124 offset:19584
  v_cvt_pk_bf16_f32 v125, v94, -v95
  ds_write_b32 v35, v125 offset:20128
  v_cvt_pk_bf16_f32 v126, v96, -v97
  ds_write_b32 v35, v126 offset:20672
  v_cvt_pk_bf16_f32 v127, v98, -v99
  ds_write_b32 v35, v127 offset:21216
  v_pk_mul_f32 v[116:117], v[92:93], v[82:83] op_sel:[0,0] op_sel_hi:[1,0]
  v_pk_fma_f32 v[92:93], v[92:93], v[82:83], v[116:117] op_sel:[1,1,0] op_sel_hi:[0,1,1] neg_lo:[1,0,0]
  v_pk_mul_f32 v[120:121], v[96:97], v[82:83] op_sel:[0,0] op_sel_hi:[1,0]
  v_pk_fma_f32 v[96:97], v[96:97], v[82:83], v[120:121] op_sel:[1,1,0] op_sel_hi:[0,1,1] neg_lo:[1,0,0]
  v_cvt_pk_bf16_f32 v124, v92, -v93
  ds_write_b32 v35, v124 offset:21760
  v_cvt_pk_bf16_f32 v125, v96, -v97
  ds_write_b32 v35, v125 offset:22304
  v_pk_mul_f32 v[116:117], v[92:93], v[82:83] op_sel:[0,0] op_sel_hi:[1,0]
  v_pk_fma_f32 v[92:93], v[92:93], v[82:83], v[116:117] op_sel:[1,1,0] op_sel_hi:[0,1,1] neg_lo:[1,0,0]
  v_pk_mul_f32 v[120:121], v[96:97], v[82:83] op_sel:[0,0] op_sel_hi:[1,0]
  v_pk_fma_f32 v[96:97], v[96:97], v[82:83], v[120:121] op_sel:[1,1,0] op_sel_hi:[0,1,1] neg_lo:[1,0,0]
  v_cvt_pk_bf16_f32 v126, v92, -v93
  ds_write_b32 v35, v126 offset:22848
  v_cvt_pk_bf16_f32 v127, v96, -v97
  ds_write_b32 v35, v127 offset:23392
  v_pk_mul_f32 v[116:117], v[92:93], v[82:83] op_sel:[0,0] op_sel_hi:[1,0]
  v_pk_fma_f32 v[92:93], v[92:93], v[82:83], v[116:117] op_sel:[1,1,0] op_sel_hi:[0,1,1] neg_lo:[1,0,0]
  v_pk_mul_f32 v[120:121], v[96:97], v[82:83] op_sel:[0,0] op_sel_hi:[1,0]
  v_pk_fma_f32 v[96:97], v[96:97], v[82:83], v[120:121] op_sel:[1,1,0] op_sel_hi:[0,1,1] neg_lo:[1,0,0]
  v_cvt_pk_bf16_f32 v124, v92, -v93
  ds_write_b32 v35, v124 offset:23936
  v_cvt_pk_bf16_f32 v125, v96, -v97
  ds_write_b32 v35, v125 offset:24480
  v_pk_mul_f32 v[116:117], v[92:93], v[82:83] op_sel:[0,0] op_sel_hi:[1,0]
  v_pk_fma_f32 v[92:93], v[92:93], v[82:83], v[116:117] op_sel:[1,1,0] op_sel_hi:[0,1,1] neg_lo:[1,0,0]
  v_pk_mul_f32 v[120:121], v[96:97], v[82:83] op_sel:[0,0] op_sel_hi:[1,0]
  v_pk_fma_f32 v[96:97], v[96:97], v[82:83], v[120:121] op_sel:[1,1,0] op_sel_hi:[0,1,1] neg_lo:[1,0,0]
  v_cvt_pk_bf16_f32 v126, v92, -v93
  ds_write_b32 v35, v126 offset:25024
  v_cvt_pk_bf16_f32 v127, v96, -v97
  ds_write_b32 v35, v127 offset:25568
  v_pk_mul_f32 v[116:117], v[92:93], v[82:83] op_sel:[0,0] op_sel_hi:[1,0]
  v_pk_fma_f32 v[92:93], v[92:93], v[82:83], v[116:117] op_sel:[1,1,0] op_sel_hi:[0,1,1] neg_lo:[1,0,0]
  v_cvt_pk_bf16_f32 v124, v92, -v93
  ds_write_b32 v35, v124 offset:26112
  v_pk_mul_f32 v[116:117], v[92:93], v[82:83] op_sel:[0,0] op_sel_hi:[1,0]
  v_pk_fma_f32 v[92:93], v[92:93], v[82:83], v[116:117] op_sel:[1,1,0] op_sel_hi:[0,1,1] neg_lo:[1,0,0]
  v_cvt_pk_bf16_f32 v125, v92, -v93
  ds_write_b32 v35, v125 offset:26656
  v_pk_mul_f32 v[116:117], v[92:93], v[82:83] op_sel:[0,0] op_sel_hi:[1,0]
  v_pk_fma_f32 v[92:93], v[92:93], v[82:83], v[116:117] op_sel:[1,1,0] op_sel_hi:[0,1,1] neg_lo:[1,0,0]
  v_cvt_pk_bf16_f32 v126, v92, -v93
  ds_write_b32 v35, v126 offset:27200
  v_pk_mul_f32 v[116:117], v[92:93], v[82:83] op_sel:[0,0] op_sel_hi:[1,0]
  v_pk_fma_f32 v[92:93], v[92:93], v[82:83], v[116:117] op_sel:[1,1,0] op_sel_hi:[0,1,1] neg_lo:[1,0,0]
  v_cvt_pk_bf16_f32 v127, v92, -v93
  ds_write_b32 v35, v127 offset:27744
  v_pk_mul_f32 v[116:117], v[92:93], v[82:83] op_sel:[0,0] op_sel_hi:[1,0]
  v_pk_fma_f32 v[92:93], v[92:93], v[82:83], v[116:117] op_sel:[1,1,0] op_sel_hi:[0,1,1] neg_lo:[1,0,0]
  v_cvt_pk_bf16_f32 v124, v92, -v93
  ds_write_b32 v35, v124 offset:28288
  v_pk_mul_f32 v[116:117], v[92:93], v[82:83] op_sel:[0,0] op_sel_hi:[1,0]
  v_pk_fma_f32 v[92:93], v[92:93], v[82:83], v[116:117] op_sel:[1,1,0] op_sel_hi:[0,1,1] neg_lo:[1,0,0]
  v_cvt_pk_bf16_f32 v125, v92, -v93
  ds_write_b32 v35, v125 offset:28832
  v_pk_mul_f32 v[116:117], v[92:93], v[82:83] op_sel:[0,0] op_sel_hi:[1,0]
  v_pk_fma_f32 v[92:93], v[92:93], v[82:83], v[116:117] op_sel:[1,1,0] op_sel_hi:[0,1,1] neg_lo:[1,0,0]
  v_cvt_pk_bf16_f32 v126, v92, -v93
  ds_write_b32 v35, v126 offset:29376
  v_pk_mul_f32 v[116:117], v[92:93], v[82:83] op_sel:[0,0] op_sel_hi:[1,0]
  v_pk_fma_f32 v[92:93], v[92:93], v[82:83], v[116:117] op_sel:[1,1,0] op_sel_hi:[0,1,1] neg_lo:[1,0,0]
  v_cvt_pk_bf16_f32 v127, v92, -v93
  ds_write_b32 v35, v127 offset:29920
  s_waitcnt vmcnt(4)
  v_and_b32 v66, v28, v108
  v_and_b32 v67, v27, v108
  v_and_b32 v68, v28, v109
  v_and_b32 v69, v27, v109
  v_and_b32 v70, v28, v110
  v_and_b32 v71, v27, v110
  v_and_b32 v72, v28, v111
  v_and_b32 v73, v27, v111
  v_dot2_f32_bf16 v74, v100, v66, 0
  v_dot2_f32_bf16 v75, v100, v67, 0
  v_dot2_f32_bf16 v76, v101, v68, 0
  v_dot2_f32_bf16 v77, v101, v69, 0
  v_dot2_f32_bf16 v78, v102, v70, 0
  v_dot2_f32_bf16 v79, v102, v71, 0
  v_dot2_f32_bf16 v80, v103, v72, 0
  v_dot2_f32_bf16 v81, v103, v73, 0
  v_dot2_f32_bf16 v82, v104, v66, 0
  v_dot2_f32_bf16 v83, v104, v67, 0
  v_dot2_f32_bf16 v84, v105, v68, 0
  v_dot2_f32_bf16 v85, v105, v69, 0
  v_dot2_f32_bf16 v86, v106, v70, 0
  v_dot2_f32_bf16 v87, v106, v71, 0
  v_dot2_f32_bf16 v88, v107, v72, 0
  v_dot2_f32_bf16 v89, v107, v73, 0
  v_cvt_pk_bf16_f32 v92, v74, v75
  v_cvt_pk_bf16_f32 v93, v76, v77
  v_cvt_pk_bf16_f32 v94, v78, v79
  v_cvt_pk_bf16_f32 v95, v80, v81
  v_cvt_pk_bf16_f32 v96, v82, v83
  v_cvt_pk_bf16_f32 v97, v84, v85
  v_cvt_pk_bf16_f32 v98, v86, v87
  v_cvt_pk_bf16_f32 v99, v88, v89
  v_lshlrev_b32 v74, 16, v92
  v_and_b32 v75, v27, v92
  v_lshlrev_b32 v76, 16, v93
  v_and_b32 v77, v27, v93
  v_lshlrev_b32 v78, 16, v94
  v_and_b32 v79, v27, v94
  v_lshlrev_b32 v80, 16, v95
  v_and_b32 v81, v27, v95
  v_lshlrev_b32 v82, 16, v96
  v_and_b32 v83, v27, v96
  v_lshlrev_b32 v84, 16, v97
  v_and_b32 v85, v27, v97
  v_lshlrev_b32 v86, 16, v98
  v_and_b32 v87, v27, v98
  v_lshlrev_b32 v88, 16, v99
  v_and_b32 v89, v27, v99
  v_add_f32 v74, v74, v75
  v_add_f32 v76, v76, v77
  v_add_f32 v78, v78, v79
  v_add_f32 v80, v80, v81
  v_add_f32 v82, v82, v83
  v_add_f32 v84, v84, v85
  v_add_f32 v86, v86, v87
  v_add_f32 v88, v88, v89
  v_add_f32 v74, v74, v76
  v_add_f32 v78, v78, v80
  v_add_f32 v82, v82, v84
  v_add_f32 v86, v86, v88
  v_add_f32 v90, v74, v78
  v_add_f32 v91, v82, v86
  s_nop 0
  v_add_f32_dpp v90, v90, v90 row_shr:1 row_mask:0xf bank_mask:0xf bound_ctrl:0
  v_add_f32_dpp v91, v91, v91 row_shr:1 row_mask:0xf bank_mask:0xf bound_ctrl:0
  s_nop 0
  v_add_f32_dpp v90, v90, v90 row_shr:2 row_mask:0xf bank_mask:0xf bound_ctrl:0
  v_add_f32_dpp v91, v91, v91 row_shr:2 row_mask:0xf bank_mask:0xf bound_ctrl:0
  s_nop 0
  v_add_f32_dpp v90, v90, v90 row_shr:4 row_mask:0xf bank_mask:0xf bound_ctrl:0
  v_add_f32_dpp v91, v91, v91 row_shr:4 row_mask:0xf bank_mask:0xf bound_ctrl:0
  s_nop 0
  v_add_f32_dpp v90, v90, v90 row_shr:8 row_mask:0xf bank_mask:0xf bound_ctrl:0
  v_add_f32_dpp v91, v91, v91 row_shr:8 row_mask:0xf bank_mask:0xf bound_ctrl:0
  s_nop 0
  v_add_f32_dpp v90, v90, v90 row_bcast:15 row_mask:0xa bank_mask:0xf
  v_add_f32_dpp v91, v91, v91 row_bcast:15 row_mask:0xa bank_mask:0xf
  s_nop 0
  v_add_f32_dpp v90, v90, v90 row_bcast:31 row_mask:0xc bank_mask:0xf
  v_add_f32_dpp v91, v91, v91 row_bcast:31 row_mask:0xc bank_mask:0xf
  v_cvt_pk_bf16_f32 v90, 0, v90
  v_cvt_pk_bf16_f32 v91, 0, v91
  v_mul_f32 v90, 0xbfb8aa3b, v90
  v_mul_f32 v91, 0xbfb8aa3b, v91
  v_exp_f32 v90, v90
  v_exp_f32 v91, v91
  v_add_f32 v90, 1.0, v90
  v_add_f32 v91, 1.0, v91
  v_rcp_f32 v90, v90
  v_rcp_f32 v91, v91
  v_cvt_pk_bf16_f32 v90, 0, v90
  v_cvt_pk_bf16_f32 v91, 0, v91
  v_sub_f32 v92, 1.0, v90
  v_sub_f32 v93, 1.0, v91
  v_cvt_pk_bf16_f32 v94, v90, v92
  v_cvt_pk_bf16_f32 v95, v91, v93
  s_lshl_b32 s77, s12, 2
  s_add_u32 s77, s77, 8388608
  v_mov_b32 v96, s77
  s_mov_b32 exec_lo, 0
  s_mov_b32 exec_hi, 0x80000000
  buffer_store_dwordx2 v[94:95], v96, s[60:63], 0 offen sc1
  s_mov_b64 exec, -1
  s_waitcnt lgkmcnt(0)
  s_barrier
  s_and_b32 s77, s96, 1
  s_mul_i32 s78, s77, 6144
  s_add_u32 s79, s78, 62464
  s_mul_i32 s77, s77, 39168
  s_add_u32 s77, s77, 74752
  v_mul_u32_u24 v66, 544, v64
  v_lshl_add_u32 v66, v65, 4, v66
  v_add_u32 v66, s77, v66
  s_cmp_gt_u32 s96, 1
  s_cbranch_scc1 L_JOB2
  ds_read_b128 a[0:3], v66 offset:0
  ds_read_b128 a[32:35], v66 offset:13056
  ds_read_b128 a[64:67], v66 offset:21760
  ds_read_b128 a[4:7], v66 offset:64
  ds_read_b128 a[36:39], v66 offset:13120
  ds_read_b128 a[68:71], v66 offset:21824
  ds_read_b128 a[8:11], v66 offset:128
  ds_read_b128 a[40:43], v66 offset:13184
  ds_read_b128 a[72:75], v66 offset:21888
  ds_read_b128 a[12:15], v66 offset:192
  ds_read_b128 a[44:47], v66 offset:13248
  ds_read_b128 a[76:79], v66 offset:21952
  ds_read_b128 a[16:19], v66 offset:256
  ds_read_b128 a[48:51], v66 offset:13312
  ds_read_b128 a[80:83], v66 offset:22016
  ds_read_b128 a[20:23], v66 offset:320
  ds_read_b128 a[52:55], v66 offset:13376
  ds_read_b128 a[84:87], v66 offset:22080
  ds_read_b128 a[24:27], v66 offset:384
  ds_read_b128 a[56:59], v66 offset:13440
  ds_read_b128 a[88:91], v66 offset:22144
  ds_read_b128 a[28:31], v66 offset:448
  ds_read_b128 a[60:63], v66 offset:13504
  ds_read_b128 a[92:95], v66 offset:22208
  v_lshlrev_b32 v68, 6, v65
  v_lshl_add_u32 v68, v64, 2, v68
  v_lshlrev_b32 v68, 1, v68
  v_add_u32 v68, s79, v68
  v_cmp_gt_u32 vcc, 2, v65
  v_lshlrev_b32 v74, 7, v65
  v_add_u32 v74, 256, v74
  v_lshlrev_b32 v75, 8, v65
  v_cndmask_b32 v70, v75, v74, vcc
  v_lshl_add_u32 v70, v64, 2, v70
  v_mov_b32 v74, 64
  v_mov_b32 v75, 2
  v_cndmask_b32 v74, v74, v75, vcc
  v_add_u32 v71, v70, v74
  v_mov_b32 v74, 128
  v_mov_b32 v75, 64
  v_cndmask_b32 v74, v74, v75, vcc
  v_add_u32 v72, v70, v74
  v_mov_b32 v74, 192
  v_mov_b32 v75, 66
  v_cndmask_b32 v74, v74, v75, vcc
  v_add_u32 v73, v70, v74
  v_lshlrev_b32 v70, 1, v70
  v_add_u32 v70, s79, v70
  v_lshlrev_b32 v71, 1, v71
  v_add_u32 v71, s79, v71
  v_lshlrev_b32 v72, 1, v72
  v_add_u32 v72, s79, v72
  v_lshlrev_b32 v73, 1, v73
  v_add_u32 v73, s79, v73
  s_waitcnt lgkmcnt(15)
  v_mfma_f32_16x16x32_bf16 v[76:79], a[32:35], a[0:3], 0
  v_mfma_f32_16x16x32_bf16 v[80:83], a[64:67], a[0:3], 0
  v_mfma_f32_16x16x32_bf16 v[76:79], a[36:39], a[4:7], v[76:79]
  v_mfma_f32_16x16x32_bf16 v[80:83], a[68:71], a[4:7], v[80:83]
  v_mfma_f32_16x16x32_bf16 v[76:79], a[40:43], a[8:11], v[76:79]
  v_mfma_f32_16x16x32_bf16 v[80:83], a[72:75], a[8:11], v[80:83]
  s_waitcnt lgkmcnt(12)
  v_mfma_f32_16x16x32_bf16 v[76:79], a[44:47], a[12:15], v[76:79]
  v_mfma_f32_16x16x32_bf16 v[80:83], a[76:79], a[12:15], v[80:83]
  s_waitcnt lgkmcnt(9)
  v_mfma_f32_16x16x32_bf16 v[76:79], a[48:51], a[16:19], v[76:79]
  v_mfma_f32_16x16x32_bf16 v[80:83], a[80:83], a[16:19], v[80:83]
  s_waitcnt lgkmcnt(6)
  v_mfma_f32_16x16x32_bf16 v[76:79], a[52:55], a[20:23], v[76:79]
  v_mfma_f32_16x16x32_bf16 v[80:83], a[84:87], a[20:23], v[80:83]
  s_waitcnt lgkmcnt(3)
  v_mfma_f32_16x16x32_bf16 v[76:79], a[56:59], a[24:27], v[76:79]
  v_mfma_f32_16x16x32_bf16 v[80:83], a[88:91], a[24:27], v[80:83]
  s_waitcnt lgkmcnt(0)
  v_mfma_f32_16x16x32_bf16 v[76:79], a[60:63], a[28:31], v[76:79]
  v_mfma_f32_16x16x32_bf16 v[80:83], a[92:95], a[28:31], v[80:83]
  s_nop 6
  v_cvt_pk_bf16_f32 v84, v76, v77
  v_cvt_pk_bf16_f32 v85, v78, v79
  ds_write_b64 v68, v[84:85]
  v_cvt_pk_bf16_f32 v86, v80, v81
  v_cvt_pk_bf16_f32 v87, v82, v83
  ds_write_b16 v70, v86
  ds_write_b16_d16_hi v71, v86
  ds_write_b16 v72, v87
  ds_write_b16_d16_hi v73, v87
  s_branch L_JOBD
L_JOB2:
  v_lshlrev_b32 v67, 1, v64
  v_add_u32 v68, 8, v64
  v_cmp_gt_u32 vcc, 8, v64
  s_nop 1
  v_cndmask_b32 v67, v68, v67, vcc
  v_mul_u32_u24 v67, 544, v67
  v_lshl_add_u32 v67, v65, 4, v67
  v_add_u32 v67, s77, v67
  ds_read_b128 a[0:3], v67 offset:0
  ds_read_b128 a[32:35], v66 offset:30464
  ds_read_b128 a[4:7], v67 offset:64
  ds_read_b128 a[36:39], v66 offset:30528
  ds_read_b128 a[8:11], v67 offset:128
  ds_read_b128 a[40:43], v66 offset:30592
  ds_read_b128 a[12:15], v67 offset:192
  ds_read_b128 a[44:47], v66 offset:30656
  ds_read_b128 a[16:19], v67 offset:256
  ds_read_b128 a[48:51], v66 offset:30720
  ds_read_b128 a[20:23], v67 offset:320
  ds_read_b128 a[52:55], v66 offset:30784
  ds_read_b128 a[24:27], v67 offset:384
  ds_read_b128 a[56:59], v66 offset:30848
  ds_read_b128 a[28:31], v67 offset:448
  ds_read_b128 a[60:63], v66 offset:30912
  v_lshlrev_b32 v70, 9, v65
  v_lshl_add_u32 v70, v64, 3, v70
  v_add_u32 v70, 1024, v70
  v_lshlrev_b32 v70, 1, v70
  v_add_u32 v70, s79, v70
  s_waitcnt lgkmcnt(14)
  v_mfma_f32_16x16x32_bf16 v[76:79], a[32:35], a[0:3], 0
  s_waitcnt lgkmcnt(12)
  v_mfma_f32_16x16x32_bf16 v[76:79], a[36:39], a[4:7], v[76:79]
  s_waitcnt lgkmcnt(10)
  v_mfma_f32_16x16x32_bf16 v[76:79], a[40:43], a[8:11], v[76:79]
  s_waitcnt lgkmcnt(8)
  v_mfma_f32_16x16x32_bf16 v[76:79], a[44:47], a[12:15], v[76:79]
  s_waitcnt lgkmcnt(6)
  v_mfma_f32_16x16x32_bf16 v[76:79], a[48:51], a[16:19], v[76:79]
  s_waitcnt lgkmcnt(4)
  v_mfma_f32_16x16x32_bf16 v[76:79], a[52:55], a[20:23], v[76:79]
  s_waitcnt lgkmcnt(2)
  v_mfma_f32_16x16x32_bf16 v[76:79], a[56:59], a[24:27], v[76:79]
  s_waitcnt lgkmcnt(0)
  v_mfma_f32_16x16x32_bf16 v[76:79], a[60:63], a[28:31], v[76:79]
  s_nop 7
  v_cvt_pk_bf16_f32 v84, v76, v77
  v_cvt_pk_bf16_f32 v85, v78, v79
  ds_write_b16 v70, v84
  ds_write_b16_d16_hi v70, v84 offset:256
  ds_write_b16 v70, v85 offset:512
  ds_write_b16_d16_hi v70, v85 offset:768
L_JOBD:
  s_waitcnt vmcnt(0)
  v_alignbit_b32 v104, v52, v48, 16
  v_alignbit_b32 v105, v53, v49, 16
  v_alignbit_b32 v106, v54, v50, 16
  v_alignbit_b32 v107, v55, v51, 16
  ds_write_b128 v31, v[48:51] offset:0
  ds_write_b128 v31, v[104:107] offset:4160
  v_alignbit_b32 v108, v60, v56, 16
  v_alignbit_b32 v109, v61, v57, 16
  v_alignbit_b32 v110, v62, v58, 16
  v_alignbit_b32 v111, v63, v59, 16
  ds_write_b128 v31, v[56:59] offset:16640
  ds_write_b128 v31, v[108:111] offset:20800
  s_cmp_eq_u32 s3, 0
  s_cbranch_scc0 L_NOPADA
  v_lshlrev_b32 v112, 2, v2
  v_add_u32 v112, 29184, v112
  v_mov_b32 v113, 0
  v_cmp_eq_u32 vcc, 7, v2
  v_readfirstlane_b32 s77, v48
  s_nop 3
  s_lshl_b32 s77, s77, 16
  v_mov_b32 v114, s77
  v_cndmask_b32 v114, 0, v114, vcc
  s_mov_b64 exec, 0xff
  ds_write_b32 v112, v113 offset:0
  ds_write_b32 v112, v114 offset:4160
  s_mov_b64 exec, -1
  v_readfirstlane_b32 s77, v56
  s_nop 3
  s_lshl_b32 s77, s77, 16
  v_mov_b32 v114, s77
  v_cndmask_b32 v114, 0, v114, vcc
  s_mov_b64 exec, 0xff
  ds_write_b32 v112, v113 offset:16640
  ds_write_b32 v112, v114 offset:20800
  s_mov_b64 exec, -1
L_NOPADA:
  s_cmp_eq_u32 s3, 3
  s_cbranch_scc0 L_NOEPW
  v_readfirstlane_b32 s72, v30
  s_nop 3
  s_add_u32 s72, s72, 1
  v_mov_b32 v84, s72
  v_mov_b32 v85, 26176
  ds_write_b32 v85, v84
L_NOEPW:
  s_waitcnt lgkmcnt(0)
  s_barrier
  s_cmp_eq_u32 s3, 2
  s_cbranch_scc0 L_NOGST
  v_mov_b32 v67, 26176
  ds_read_b32 v66, v67
  s_lshl_b32 s77, s2, 3
  s_add_u32 s77, s77, 8454144
  v_mov_b32 v68, s77
  s_waitcnt lgkmcnt(0)
  v_xor_b32 v67, 0x5a5a5a5a, v66
  s_mov_b64 exec, 1
  buffer_store_dwordx2 v[66:67], v68, s[60:63], 0 offen sc1
  s_mov_b64 exec, -1
L_NOGST:
  ds_read_u16 v66, v36 offset:0
  ds_read_u16 v67, v37 offset:0
  ds_read_u16 v68, v38 offset:0
  ds_read_u16 v69, v39 offset:0
  ds_read_u16 v70, v40 offset:0
  ds_read_u16 v71, v41 offset:0
  ds_read_u16 v72, v42 offset:0
  ds_read_u16 v73, v43 offset:0
  ds_read_u16 v74, v44 offset:0
  ds_read_u16 v76, v36 offset:6144
  ds_read_u16 v77, v37 offset:6144
  ds_read_u16 v78, v38 offset:6144
  ds_read_u16 v79, v39 offset:6144
  ds_read_u16 v80, v40 offset:6144
  ds_read_u16 v81, v41 offset:6144
  ds_read_u16 v82, v42 offset:6144
  ds_read_u16 v83, v43 offset:6144
  ds_read_u16 v84, v44 offset:6144
  s_waitcnt lgkmcnt(0)
  v_lshl_or_b32 v88, v67, 16, v66
  v_lshl_or_b32 v92, v68, 16, v67
  v_lshl_or_b32 v89, v69, 16, v68
  v_lshl_or_b32 v93, v70, 16, v69
  v_lshl_or_b32 v90, v71, 16, v70
  v_lshl_or_b32 v94, v72, 16, v71
  v_lshl_or_b32 v91, v73, 16, v72
  v_lshl_or_b32 v95, v74, 16, v73
  ds_write_b128 v31, v[88:91] offset:8320
  ds_write_b128 v31, v[92:95] offset:12480
  v_lshl_or_b32 v96, v77, 16, v76
  v_lshl_or_b32 v100, v78, 16, v77
  v_lshl_or_b32 v97, v79, 16, v78
  v_lshl_or_b32 v101, v80, 16, v79
  v_lshl_or_b32 v98, v81, 16, v80
  v_lshl_or_b32 v102, v82, 16, v81
  v_lshl_or_b32 v99, v83, 16, v82
  v_lshl_or_b32 v103, v84, 16, v83
  ds_write_b128 v31, v[96:99] offset:24960
  ds_write_b128 v31, v[100:103] offset:29120
  s_cmp_eq_u32 s3, 0
  s_cbranch_scc0 L_NOPADB
  v_lshlrev_b32 v112, 2, v2
  v_add_u32 v112, 29184, v112
  v_mov_b32 v113, 0
  v_cmp_eq_u32 vcc, 7, v2
  v_readfirstlane_b32 s77, v66
  s_nop 3
  s_lshl_b32 s77, s77, 16
  v_mov_b32 v114, s77
  v_cndmask_b32 v114, 0, v114, vcc
  s_mov_b64 exec, 0xff
  ds_write_b32 v112, v113 offset:8320
  ds_write_b32 v112, v114 offset:12480
  s_mov_b64 exec, -1
  v_readfirstlane_b32 s77, v76
  s_nop 3
  s_lshl_b32 s77, s77, 16
  v_mov_b32 v114, s77
  v_cndmask_b32 v114, 0, v114, vcc
  s_mov_b64 exec, 0xff
  ds_write_b32 v112, v113 offset:24960
  ds_write_b32 v112, v114 offset:29120
  s_mov_b64 exec, -1
L_NOPADB:
  s_cmp_eq_u32 s8, 0
  s_cbranch_scc0 L_KNOAL
  ds_read2_b32 a[0:1], v17 offset0:0 offset1:1
  ds_read2_b32 a[2:3], v17 offset0:2 offset1:3
  ds_read2_b32 a[4:5], v17 offset0:16 offset1:17
  ds_read2_b32 a[6:7], v17 offset0:18 offset1:19
  ds_read2_b32 a[8:9], v17 offset0:32 offset1:33
  ds_read2_b32 a[10:11], v17 offset0:34 offset1:35
  ds_read2_b32 a[12:13], v17 offset0:48 offset1:49
  ds_read2_b32 a[14:15], v17 offset0:50 offset1:51
  ds_read2_b32 a[16:17], v17 offset0:128 offset1:129
  ds_read2_b32 a[18:19], v17 offset0:130 offset1:131
  ds_read2_b32 a[20:21], v17 offset0:144 offset1:145
  ds_read2_b32 a[22:23], v17 offset0:146 offset1:147
  ds_read2_b32 a[24:25], v17 offset0:160 offset1:161
  ds_read2_b32 a[26:27], v17 offset0:162 offset1:163
  ds_read2_b32 a[28:29], v17 offset0:176 offset1:177
  ds_read2_b32 a[30:31], v17 offset0:178 offset1:179
  ds_read2_b32 a[32:33], v18 offset0:0 offset1:1
  ds_read2_b32 a[34:35], v18 offset0:2 offset1:3
  ds_read2_b32 a[36:37], v18 offset0:16 offset1:17
  ds_read2_b32 a[38:39], v18 offset0:18 offset1:19
  ds_read2_b32 a[40:41], v18 offset0:32 offset1:33
  ds_read2_b32 a[42:43], v18 offset0:34 offset1:35
  ds_read2_b32 a[44:45], v18 offset0:48 offset1:49
  ds_read2_b32 a[46:47], v18 offset0:50 offset1:51
  ds_read2_b32 a[48:49], v18 offset0:128 offset1:129
  ds_read2_b32 a[50:51], v18 offset0:130 offset1:131
  ds_read2_b32 a[52:53], v18 offset0:144 offset1:145
  ds_read2_b32 a[54:55], v18 offset0:146 offset1:147
  ds_read2_b32 a[56:57], v18 offset0:160 offset1:161
  ds_read2_b32 a[58:59], v18 offset0:162 offset1:163
  ds_read2_b32 a[60:61], v18 offset0:176 offset1:177
  ds_read2_b32 a[62:63], v18 offset0:178 offset1:179
  ds_read2_b32 a[64:65], v19 offset0:0 offset1:1
  ds_read2_b32 a[66:67], v19 offset0:2 offset1:3
  ds_read2_b32 a[68:69], v19 offset0:16 offset1:17
  ds_read2_b32 a[70:71], v19 offset0:18 offset1:19
  ds_read2_b32 a[72:73], v19 offset0:32 offset1:33
  ds_read2_b32 a[74:75], v19 offset0:34 offset1:35
  ds_read2_b32 a[76:77], v19 offset0:48 offset1:49
  ds_read2_b32 a[78:79], v19 offset0:50 offset1:51
  ds_read2_b32 a[80:81], v19 offset0:128 offset1:129
  ds_read2_b32 a[82:83], v19 offset0:130 offset1:131
  ds_read2_b32 a[84:85], v19 offset0:144 offset1:145
  ds_read2_b32 a[86:87], v19 offset0:146 offset1:147
  ds_read2_b32 a[88:89], v19 offset0:160 offset1:161
  ds_read2_b32 a[90:91], v19 offset0:162 offset1:163
  ds_read2_b32 a[92:93], v19 offset0:176 offset1:177
  ds_read2_b32 a[94:95], v19 offset0:178 offset1:179
  ds_read2_b32 a[96:97], v20 offset0:0 offset1:1
  ds_read2_b32 a[98:99], v20 offset0:2 offset1:3
  ds_read2_b32 a[100:101], v20 offset0:16 offset1:17
  ds_read2_b32 a[102:103], v20 offset0:18 offset1:19
  ds_read2_b32 a[104:105], v20 offset0:32 offset1:33
  ds_read2_b32 a[106:107], v20 offset0:34 offset1:35
  ds_read2_b32 a[108:109], v20 offset0:48 offset1:49
  ds_read2_b32 a[110:111], v20 offset0:50 offset1:51
  ds_read2_b32 a[112:113], v20 offset0:128 offset1:129
  ds_read2_b32 a[114:115], v20 offset0:130 offset1:131
  ds_read2_b32 a[116:117], v20 offset0:144 offset1:145
  ds_read2_b32 a[118:119], v20 offset0:146 offset1:147
  ds_read2_b32 a[120:121], v20 offset0:160 offset1:161
  ds_read2_b32 a[122:123], v20 offset0:162 offset1:163
  ds_read2_b32 a[124:125], v20 offset0:176 offset1:177
  ds_read2_b32 a[126:127], v20 offset0:178 offset1:179
  s_waitcnt lgkmcnt(15)
  s_branch L_KAL2
L_KNOAL:
  s_waitcnt lgkmcnt(0)
L_KAL2:
  s_cmp_eq_u32 s8, 0
  s_cselect_b32 s77, s100, s101
  s_lshl_b32 s78, s9, 4
  s_lshr_b32 s77, s77, s78
  s_lshl_b32 s77, s77, 16
  v_mov_b32 v26, s77
  s_barrier
L_JOIN:
  v_mov_b32 v101, 26176
  ds_read_b32 v100, v101
  v_mov_b32 v104, 0
  v_mov_b32 v105, 0
  ds_write_b64 v29, v[104:105]
  s_waitcnt lgkmcnt(0)
  v_readfirstlane_b32 s72, v100
  s_nop 3
  s_xor_b32 s73, s72, 0x5a5a5a5a
  s_add_u32 s97, s97, s73
  v_lshlrev_b32 v122, 5, v2
  v_add_u32 v122, 8454144, v122
  v_and_b32 v123, 31, v2
  v_lshlrev_b32 v123, 3, v123
  s_lshl_b32 s77, s4, 8
  s_add_u32 s77, s77, 8585216
  v_add_u32 v123, s77, v123
  s_cmp_eq_u32 s8, 0
  s_cbranch_scc1 L_SKIPAL
  ds_read2_b32 a[0:1], v17 offset0:0 offset1:1
  ds_read2_b32 a[2:3], v17 offset0:2 offset1:3
  ds_read2_b32 a[4:5], v17 offset0:16 offset1:17
  ds_read2_b32 a[6:7], v17 offset0:18 offset1:19
  ds_read2_b32 a[8:9], v17 offset0:32 offset1:33
  ds_read2_b32 a[10:11], v17 offset0:34 offset1:35
  ds_read2_b32 a[12:13], v17 offset0:48 offset1:49
  ds_read2_b32 a[14:15], v17 offset0:50 offset1:51
  ds_read2_b32 a[16:17], v17 offset0:128 offset1:129
  ds_read2_b32 a[18:19], v17 offset0:130 offset1:131
  ds_read2_b32 a[20:21], v17 offset0:144 offset1:145
  ds_read2_b32 a[22:23], v17 offset0:146 offset1:147
  ds_read2_b32 a[24:25], v17 offset0:160 offset1:161
  ds_read2_b32 a[26:27], v17 offset0:162 offset1:163
  ds_read2_b32 a[28:29], v17 offset0:176 offset1:177
  ds_read2_b32 a[30:31], v17 offset0:178 offset1:179
  ds_read2_b32 a[32:33], v18 offset0:0 offset1:1
  ds_read2_b32 a[34:35], v18 offset0:2 offset1:3
  ds_read2_b32 a[36:37], v18 offset0:16 offset1:17
  ds_read2_b32 a[38:39], v18 offset0:18 offset1:19
  ds_read2_b32 a[40:41], v18 offset0:32 offset1:33
  ds_read2_b32 a[42:43], v18 offset0:34 offset1:35
  ds_read2_b32 a[44:45], v18 offset0:48 offset1:49
  ds_read2_b32 a[46:47], v18 offset0:50 offset1:51
  ds_read2_b32 a[48:49], v18 offset0:128 offset1:129
  ds_read2_b32 a[50:51], v18 offset0:130 offset1:131
  ds_read2_b32 a[52:53], v18 offset0:144 offset1:145
  ds_read2_b32 a[54:55], v18 offset0:146 offset1:147
  ds_read2_b32 a[56:57], v18 offset0:160 offset1:161
  ds_read2_b32 a[58:59], v18 offset0:162 offset1:163
  ds_read2_b32 a[60:61], v18 offset0:176 offset1:177
  ds_read2_b32 a[62:63], v18 offset0:178 offset1:179
  ds_read2_b32 a[64:65], v19 offset0:0 offset1:1
  ds_read2_b32 a[66:67], v19 offset0:2 offset1:3
  ds_read2_b32 a[68:69], v19 offset0:16 offset1:17
  ds_read2_b32 a[70:71], v19 offset0:18 offset1:19
  ds_read2_b32 a[72:73], v19 offset0:32 offset1:33
  ds_read2_b32 a[74:75], v19 offset0:34 offset1:35
  ds_read2_b32 a[76:77], v19 offset0:48 offset1:49
  ds_read2_b32 a[78:79], v19 offset0:50 offset1:51
  ds_read2_b32 a[80:81], v19 offset0:128 offset1:129
  ds_read2_b32 a[82:83], v19 offset0:130 offset1:131
  ds_read2_b32 a[84:85], v19 offset0:144 offset1:145
  ds_read2_b32 a[86:87], v19 offset0:146 offset1:147
  ds_read2_b32 a[88:89], v19 offset0:160 offset1:161
  ds_read2_b32 a[90:91], v19 offset0:162 offset1:163
  ds_read2_b32 a[92:93], v19 offset0:176 offset1:177
  ds_read2_b32 a[94:95], v19 offset0:178 offset1:179
  ds_read2_b32 a[96:97], v20 offset0:0 offset1:1
  ds_read2_b32 a[98:99], v20 offset0:2 offset1:3
  ds_read2_b32 a[100:101], v20 offset0:16 offset1:17
  ds_read2_b32 a[102:103], v20 offset0:18 offset1:19
  ds_read2_b32 a[104:105], v20 offset0:32 offset1:33
  ds_read2_b32 a[106:107], v20 offset0:34 offset1:35
  ds_read2_b32 a[108:109], v20 offset0:48 offset1:49
  ds_read2_b32 a[110:111], v20 offset0:50 offset1:51
  ds_read2_b32 a[112:113], v20 offset0:128 offset1:129
  ds_read2_b32 a[114:115], v20 offset0:130 offset1:131
  ds_read2_b32 a[116:117], v20 offset0:144 offset1:145
  ds_read2_b32 a[118:119], v20 offset0:146 offset1:147
  ds_read2_b32 a[120:121], v20 offset0:160 offset1:161
  ds_read2_b32 a[122:123], v20 offset0:162 offset1:163
  ds_read2_b32 a[124:125], v20 offset0:176 offset1:177
  ds_read2_b32 a[126:127], v20 offset0:178 offset1:179
L_SKIPAL:
  s_cmp_eq_u32 s3, 5
  s_cbranch_scc0 L_NOTG
  s_mov_b32 s77, 0
L_GPOLL:
  buffer_load_dwordx4 v[112:115], v122, s[60:63], 0 offen sc1
  buffer_load_dwordx4 v[116:119], v122, s[60:63], 0 offen offset:16 sc1
  s_waitcnt vmcnt(0)
  v_xor_b32 v112, s72, v112
  v_xor_b32 v114, s72, v114
  v_xor_b32 v116, s72, v116
  v_xor_b32 v118, s72, v118
  v_xor_b32 v113, s73, v113
  v_xor_b32 v115, s73, v115
  v_xor_b32 v117, s73, v117
  v_xor_b32 v119, s73, v119
  v_or_b32 v112, v112, v113
  v_or_b32 v114, v114, v115
  v_or_b32 v116, v116, v117
  v_or_b32 v118, v118, v119
  v_or_b32 v112, v112, v114
  v_or_b32 v116, v116, v118
  v_or_b32 v112, v112, v116
  v_cmp_ne_u32 vcc, 0, v112
  s_add_u32 s77, s77, 1
  s_nop 3
  s_cmp_eq_u64 vcc, 0
  s_cbranch_scc1 L_GOK
  s_cmp_lt_u32 s77, 20000
  s_cbranch_scc1 L_GPOLL
L_GOK:
  v_lshlrev_b32 v112, 4, v2
  s_mov_b32 m0, 93184
  s_mov_b32 s77, 8388608
  buffer_load_dwordx4 v112, s[60:63], s77 offen sc1 lds
  s_mov_b32 m0, 94208
  s_mov_b32 s77, 8389632
  buffer_load_dwordx4 v112, s[60:63], s77 offen sc1 lds
  s_mov_b32 m0, 95232
  s_mov_b32 s77, 8390656
  buffer_load_dwordx4 v112, s[60:63], s77 offen sc1 lds
  s_mov_b32 m0, 96256
  s_mov_b32 s77, 8391680
  buffer_load_dwordx4 v112, s[60:63], s77 offen sc1 lds
  s_mov_b32 m0, 97280
  s_mov_b32 s77, 8392704
  buffer_load_dwordx4 v112, s[60:63], s77 offen sc1 lds
  s_mov_b32 m0, 98304
  s_mov_b32 s77, 8393728
  buffer_load_dwordx4 v112, s[60:63], s77 offen sc1 lds
  s_mov_b32 m0, 99328
  s_mov_b32 s77, 8394752
  buffer_load_dwordx4 v112, s[60:63], s77 offen sc1 lds
  s_mov_b32 m0, 100352
  s_mov_b32 s77, 8395776
  buffer_load_dwordx4 v112, s[60:63], s77 offen sc1 lds
  s_branch L_POLLDONE
L_NOTG:
  s_cmp_eq_u32 s3, 7
  s_cbranch_scc0 L_POLLDONE
  s_mov_b32 s77, 0
L_POLL:
  buffer_load_dwordx2 v[120:121], v123, s[60:63], 0 offen sc1
  s_waitcnt vmcnt(0)
  v_xor_b32 v120, s72, v120
  v_xor_b32 v121, s97, v121
  v_or_b32 v120, v120, v121
  v_cmp_ne_u32 vcc, 0, v120
  s_add_u32 s77, s77, 1
  s_mov_b32 s98, 1
  s_nop 2
  s_cmp_eq_u64 vcc, 0
  s_cbranch_scc1 L_POLLOUT
  s_cmp_lt_u32 s77, 12
  s_cbranch_scc1 L_POLL
  s_mov_b32 s98, 2
L_POLLOUT:
  v_mov_b32 v120, s98
  v_mov_b32 v121, 26240
  ds_write_b32 v121, v120
L_POLLDONE:
  s_waitcnt lgkmcnt(0)
  s_barrier
  v_mov_b32 v121, 26240
  ds_read_b32 v120, v121
  s_mov_b32 s99, 0
  s_waitcnt lgkmcnt(0)
  v_readfirstlane_b32 s98, v120
  s_nop 3
  s_cmp_eq_u32 s98, 1
  s_cbranch_scc1 L_FAST
  s_cmp_eq_u32 s7, 0
  s_cbranch_scc1 L_FBK
  ds_read_b64_tr_b16 v[32:33], v5 offset:17920
  ds_read_b64_tr_b16 v[34:35], v5 offset:17408
  ds_read_b64_tr_b16 v[36:37], v5 offset:22016
  ds_read_b64_tr_b16 v[38:39], v5 offset:21504
  ds_read_b64_tr_b16 v[40:41], v5 offset:9728
  ds_read_b64_tr_b16 v[42:43], v5 offset:9216
  ds_read_b64_tr_b16 v[44:45], v5 offset:13824
  ds_read_b64_tr_b16 v[46:47], v5 offset:13312
  s_mov_b32 s77, 6291456
  s_mov_b32 s78, 4194304
  s_waitcnt lgkmcnt(6)
  buffer_store_dwordx4 v[32:35], v6, s[60:63], s77 offen offset:64 sc1
  s_waitcnt lgkmcnt(4)
  buffer_store_dwordx4 v[36:39], v6, s[60:63], s77 offen offset:0 sc1
  s_waitcnt lgkmcnt(2)
  buffer_store_dwordx4 v[40:43], v6, s[60:63], s78 offen offset:64 sc1
  s_waitcnt lgkmcnt(0)
  buffer_store_dwordx4 v[44:47], v6, s[60:63], s78 offen offset:0 sc1
L_FBK:
  s_waitcnt vmcnt(0)
  s_barrier
  s_cmp_eq_u32 s3, 7
  s_cbranch_scc0 L_FB2
  v_mov_b32 v120, s72
  v_mov_b32 v121, s73
  s_lshl_b32 s77, s4, 5
  s_add_u32 s77, s77, s5
  s_lshl_b32 s77, s77, 3
  s_add_u32 s78, s77, 8519680
  v_mov_b32 v124, s78
  s_mov_b64 exec, 1
  buffer_store_dwordx2 v[120:121], v124, s[60:63], 0 offen sc1
  s_mov_b64 exec, -1
  v_add_u32 v124, -65536, v123
  s_mov_b32 s77, 0
L_FBPOLL:
  buffer_load_dwordx2 v[120:121], v123, s[60:63], 0 offen sc1
  buffer_load_dwordx2 v[126:127], v124, s[60:63], 0 offen sc1
  s_waitcnt vmcnt(0)
  v_xor_b32 v120, s72, v120
  v_xor_b32 v121, s97, v121
  v_or_b32 v120, v120, v121
  v_xor_b32 v126, s72, v126
  v_xor_b32 v127, s73, v127
  v_or_b32 v126, v126, v127
  s_add_u32 s77, s77, 1
  s_cmp_ge_u32 s77, 20000
  s_cbranch_scc1 L_FBGIVE
  v_cmp_ne_u32 vcc, 0, v120
  s_mov_b32 s98, 1
  s_nop 3
  s_cmp_eq_u64 vcc, 0
  s_cbranch_scc1 L_FBOUT
  v_cmp_ne_u32 vcc, 0, v126
  s_nop 4
  s_cmp_eq_u64 vcc, 0
  s_cbranch_scc0 L_FBPOLL
L_FBGIVE:
  s_mov_b32 s98, 2
L_FBOUT:
  v_mov_b32 v120, s98
  v_mov_b32 v121, 26240
  ds_write_b32 v121, v120
  s_waitcnt lgkmcnt(0)
L_FB2:
  s_barrier
  v_mov_b32 v121, 26240
  ds_read_b32 v120, v121
  s_waitcnt lgkmcnt(0)
  v_readfirstlane_b32 s98, v120
  s_nop 3
  s_cmp_eq_u32 s98, 2
  s_cselect_b32 s99, 4194304, 0
L_FAST:
  s_cmp_eq_u32 s3, 5
  s_cbranch_scc1 L_XDONE
  s_cmp_gt_u32 s3, 5
  s_cselect_b32 s78, 1, 0
  s_sub_u32 s78, s3, s78
  v_lshlrev_b32 v112, 4, v2
  s_add_u32 s79, s13, s99
  s_lshr_b32 s74, s78, 2
  s_and_b32 s75, s78, 3
  s_lshl_b32 s75, s75, 10
  s_mul_i32 s76, s74, 4608
  s_add_u32 s76, s76, s75
  s_add_u32 m0, s76, 74752
  s_lshr_b32 s76, s74, 1
  s_lshl_b32 s76, s76, 12
  s_add_u32 s75, s75, s76
  s_and_b32 s74, s74, 1
  s_xor_b32 s74, s74, 1
  s_lshl_b32 s74, s74, 21
  s_add_u32 s75, s75, s74
  s_add_u32 s75, s75, s79
  buffer_load_dwordx4 v112, s[60:63], s75 offen sc1 lds
  s_add_u32 s78, s78, 7
  s_lshr_b32 s74, s78, 2
  s_and_b32 s75, s78, 3
  s_lshl_b32 s75, s75, 10
  s_mul_i32 s76, s74, 4608
  s_add_u32 s76, s76, s75
  s_add_u32 m0, s76, 74752
  s_lshr_b32 s76, s74, 1
  s_lshl_b32 s76, s76, 12
  s_add_u32 s75, s75, s76
  s_and_b32 s74, s74, 1
  s_xor_b32 s74, s74, 1
  s_lshl_b32 s74, s74, 21
  s_add_u32 s75, s75, s74
  s_add_u32 s75, s75, s79
  buffer_load_dwordx4 v112, s[60:63], s75 offen sc1 lds
  s_add_u32 s78, s78, 7
  s_cmp_gt_u32 s78, 15
  s_cbranch_scc1 L_XW
  s_lshr_b32 s74, s78, 2
  s_and_b32 s75, s78, 3
  s_lshl_b32 s75, s75, 10
  s_mul_i32 s76, s74, 4608
  s_add_u32 s76, s76, s75
  s_add_u32 m0, s76, 74752
  s_lshr_b32 s76, s74, 1
  s_lshl_b32 s76, s76, 12
  s_add_u32 s75, s75, s76
  s_and_b32 s74, s74, 1
  s_xor_b32 s74, s74, 1
  s_lshl_b32 s74, s74, 21
  s_add_u32 s75, s75, s74
  s_add_u32 s75, s75, s79
  buffer_load_dwordx4 v112, s[60:63], s75 offen sc1 lds
  s_add_u32 s78, s78, 7
L_XW:
  s_waitcnt vmcnt(0)
L_XDONE:
  s_waitcnt lgkmcnt(0)
  s_barrier
  s_cmp_lg_u32 s2, 0
  s_cbranch_scc1 L_NOEP
  s_cmp_lg_u32 s3, 7
  s_cbranch_scc1 L_NOEP
  v_mov_b32 v72, s72
  v_mov_b32 v73, 8650752
  s_mov_b64 exec, 1
  buffer_store_dword v72, v73, s[60:63], 0 offen
  s_mov_b64 exec, -1
L_NOEP:
  s_cmp_lg_u32 s7, 0
  s_cbranch_scc1 L_H1
  v_mov_b32 v27, 0xffff0000
  ds_read_b128 v[48:51], v8 offset:3584
  ds_read_b128 v[52:55], v8 offset:3648
  ds_read_b128 v[56:59], v8 offset:3712
  ds_read_b128 v[60:63], v8 offset:3776
  ds_read_b128 v[64:67], v8 offset:3584
  ds_read_b128 v[68:71], v8 offset:3072
  ds_read_b128 v[72:75], v8 offset:2560
  ds_read_b128 v[76:79], v8 offset:3648
  ds_read_b128 v[80:83], v8 offset:3136
  ds_read_b128 v[84:87], v8 offset:2624
  ds_read_b128 v[88:91], v8 offset:3712
  ds_read_b128 v[92:95], v8 offset:3200
  s_waitcnt vmcnt(0)
  s_barrier
  ds_read_b128 v[32:35], v12 offset:0
  s_waitcnt lgkmcnt(10)
  s_waitcnt lgkmcnt(0)
  v_mfma_f32_16x16x32_bf16 v[32:35], a[0:3], v[48:51], v[32:35]
  ds_read_b64 v[120:121], v9 offset:3584
  ds_read_b64 v[122:123], v10 offset:3584
  ds_read_b128 v[104:107], v11 offset:0
  ds_read_b128 v[48:51], v8 offset:2688
  v_mfma_f32_16x16x32_bf16 v[32:35], a[4:7], v[52:55], v[32:35]
  ds_read_b128 v[52:55], v8 offset:3776
  v_mfma_f32_16x16x32_bf16 v[32:35], a[8:11], v[56:59], v[32:35]
  ds_read_b128 v[56:59], v8 offset:3264
  v_mfma_f32_16x16x32_bf16 v[32:35], a[12:15], v[60:63], v[32:35]
  s_waitcnt lgkmcnt(3)
  v_lshlrev_b32 v99, 16, v120
  v_and_b32 v98, v27, v120
  v_lshlrev_b32 v97, 16, v121
  v_and_b32 v96, v27, v121
  v_perm_b32 v103, v122, v24, v22
  v_perm_b32 v102, v122, v24, v23
  v_perm_b32 v101, v123, v24, v22
  v_perm_b32 v100, v123, v24, v23
  v_mul_f32 v96, v26, v96
  v_mul_f32 v97, v26, v97
  v_mul_f32 v98, v26, v98
  v_mul_f32 v99, v26, v99
  v_perm_b32 v104, v104, v104, v25
  v_perm_b32 v105, v105, v105, v25
  v_perm_b32 v106, v106, v106, v25
  v_perm_b32 v107, v107, v107, v25
  v_cvt_pk_bf16_f32 v96, 0, v96
  v_cvt_pk_bf16_f32 v97, 0, v97
  v_cvt_pk_bf16_f32 v98, 0, v98
  v_cvt_pk_bf16_f32 v99, 0, v99
  ds_read_b128 v[60:63], v8 offset:2752
  v_cvt_pk_bf16_f32 v32, 0, v32
  v_cvt_pk_bf16_f32 v33, 0, v33
  v_cvt_pk_bf16_f32 v34, 0, v34
  v_cvt_pk_bf16_f32 v35, 0, v35
  v_add_f32 v32, v32, v96
  v_add_f32 v33, v33, v97
  v_add_f32 v34, v34, v98
  v_add_f32 v35, v35, v99
  v_cvt_pk_bf16_f32 v32, 0, v32
  v_cvt_pk_bf16_f32 v33, 0, v33
  v_cvt_pk_bf16_f32 v34, 0, v34
  v_cvt_pk_bf16_f32 v35, 0, v35
  v_mul_f32 v32, v32, v100
  v_mul_f32 v33, v33, v101
  v_mul_f32 v34, v34, v102
  v_mul_f32 v35, v35, v103
  v_cvt_pk_bf16_f32 v32, 0, v32
  v_cvt_pk_bf16_f32 v33, 0, v33
  v_cvt_pk_bf16_f32 v34, 0, v34
  v_cvt_pk_bf16_f32 v35, 0, v35
  v_mul_f32 v32, v32, v104
  v_mul_f32 v33, v33, v105
  v_mul_f32 v34, v34, v106
  v_mul_f32 v35, v35, v107
  v_cvt_pk_bf16_f32 v124, v32, v33
  v_cvt_pk_bf16_f32 v125, v34, v35
  ds_write_b64 v14, v[124:125] offset:0
  s_waitcnt lgkmcnt(0)
  s_barrier
  ds_read_b128 v[40:43], v12 offset:1024
  ds_read_b128 v[44:47], v12 offset:2048
  s_waitcnt lgkmcnt(1)
  v_mfma_f32_16x16x32_bf16 v[40:43], a[16:19], v[64:67], v[40:43]
  ds_read_b64 v[120:121], v9 offset:3072
  ds_read_b64 v[122:123], v10 offset:3072
  ds_read_b128 v[104:107], v11 offset:1024
  s_waitcnt lgkmcnt(3)
  v_mfma_f32_16x16x32_bf16 v[44:47], a[32:35], v[64:67], v[44:47]
  ds_read_b128 v[64:67], v8 offset:3584
  v_mfma_f32_16x16x32_bf16 v[40:43], a[0:3], v[68:71], v[40:43]
  v_mfma_f32_16x16x32_bf16 v[44:47], a[16:19], v[68:71], v[44:47]
  ds_read_b128 v[68:71], v8 offset:3072
  v_mfma_f32_16x16x32_bf16 v[44:47], a[0:3], v[72:75], v[44:47]
  ds_read_b128 v[72:75], v8 offset:2560
  v_mfma_f32_16x16x32_bf16 v[40:43], a[20:23], v[76:79], v[40:43]
  s_waitcnt lgkmcnt(3)
  v_lshlrev_b32 v99, 16, v120
  v_and_b32 v98, v27, v120
  v_mfma_f32_16x16x32_bf16 v[44:47], a[36:39], v[76:79], v[44:47]
  v_lshlrev_b32 v97, 16, v121
  v_and_b32 v96, v27, v121
  ds_read_b128 v[76:79], v8 offset:2048
  v_mfma_f32_16x16x32_bf16 v[40:43], a[4:7], v[80:83], v[40:43]
  v_perm_b32 v103, v122, v24, v22
  v_perm_b32 v102, v122, v24, v23
  v_mfma_f32_16x16x32_bf16 v[44:47], a[20:23], v[80:83], v[44:47]
  v_perm_b32 v101, v123, v24, v22
  v_perm_b32 v100, v123, v24, v23
  ds_read_b128 v[80:83], v8 offset:1536
  v_mfma_f32_16x16x32_bf16 v[44:47], a[4:7], v[84:87], v[44:47]
  v_mul_f32 v96, v26, v96
  v_mul_f32 v97, v26, v97
  ds_read_b128 v[84:87], v8 offset:3648
  v_mfma_f32_16x16x32_bf16 v[40:43], a[24:27], v[88:91], v[40:43]
  v_mul_f32 v98, v26, v98
  v_mul_f32 v99, v26, v99
  v_mfma_f32_16x16x32_bf16 v[44:47], a[40:43], v[88:91], v[44:47]
  v_perm_b32 v104, v104, v104, v25
  v_perm_b32 v105, v105, v105, v25
  ds_read_b128 v[88:91], v8 offset:3136
  v_mfma_f32_16x16x32_bf16 v[40:43], a[8:11], v[92:95], v[40:43]
  v_perm_b32 v106, v106, v106, v25
  v_perm_b32 v107, v107, v107, v25
  v_mfma_f32_16x16x32_bf16 v[44:47], a[24:27], v[92:95], v[44:47]
  v_cvt_pk_bf16_f32 v96, 0, v96
  v_cvt_pk_bf16_f32 v97, 0, v97
  ds_read_b128 v[92:95], v8 offset:2624
  v_mfma_f32_16x16x32_bf16 v[44:47], a[8:11], v[48:51], v[44:47]
  v_cvt_pk_bf16_f32 v98, 0, v98
  v_cvt_pk_bf16_f32 v99, 0, v99
  ds_read_b64 v[120:121], v9 offset:2560
  ds_read_b64 v[122:123], v10 offset:2560
  ds_read_b128 v[116:119], v11 offset:2048
  ds_read_b128 v[48:51], v8 offset:2112
  v_mfma_f32_16x16x32_bf16 v[40:43], a[28:31], v[52:55], v[40:43]
  v_mfma_f32_16x16x32_bf16 v[44:47], a[44:47], v[52:55], v[44:47]
  ds_read_b128 v[52:55], v8 offset:1600
  v_mfma_f32_16x16x32_bf16 v[40:43], a[12:15], v[56:59], v[40:43]
  v_mfma_f32_16x16x32_bf16 v[44:47], a[28:31], v[56:59], v[44:47]
  ds_read_b128 v[56:59], v8 offset:3712
  s_waitcnt lgkmcnt(12)
  v_mfma_f32_16x16x32_bf16 v[44:47], a[12:15], v[60:63], v[44:47]
  s_waitcnt lgkmcnt(3)
  v_lshlrev_b32 v111, 16, v120
  v_and_b32 v110, v27, v120
  v_lshlrev_b32 v109, 16, v121
  v_and_b32 v108, v27, v121
  v_perm_b32 v115, v122, v24, v22
  v_perm_b32 v114, v122, v24, v23
  v_perm_b32 v113, v123, v24, v22
  v_perm_b32 v112, v123, v24, v23
  v_mul_f32 v108, v26, v108
  v_mul_f32 v109, v26, v109
  v_mul_f32 v110, v26, v110
  v_mul_f32 v111, v26, v111
  v_perm_b32 v116, v116, v116, v25
  v_perm_b32 v117, v117, v117, v25
  v_perm_b32 v118, v118, v118, v25
  v_perm_b32 v119, v119, v119, v25
  v_cvt_pk_bf16_f32 v108, 0, v108
  v_cvt_pk_bf16_f32 v109, 0, v109
  v_cvt_pk_bf16_f32 v110, 0, v110
  v_cvt_pk_bf16_f32 v111, 0, v111
  ds_read_b128 v[60:63], v8 offset:3200
  v_cvt_pk_bf16_f32 v40, 0, v40
  v_cvt_pk_bf16_f32 v41, 0, v41
  v_cvt_pk_bf16_f32 v42, 0, v42
  v_cvt_pk_bf16_f32 v43, 0, v43
  v_cvt_pk_bf16_f32 v44, 0, v44
  v_cvt_pk_bf16_f32 v45, 0, v45
  v_cvt_pk_bf16_f32 v46, 0, v46
  v_cvt_pk_bf16_f32 v47, 0, v47
  v_add_f32 v40, v40, v96
  v_add_f32 v41, v41, v97
  v_add_f32 v42, v42, v98
  v_add_f32 v43, v43, v99
  v_add_f32 v44, v44, v108
  v_add_f32 v45, v45, v109
  v_add_f32 v46, v46, v110
  v_add_f32 v47, v47, v111
  v_cvt_pk_bf16_f32 v40, 0, v40
  v_cvt_pk_bf16_f32 v41, 0, v41
  v_cvt_pk_bf16_f32 v42, 0, v42
  v_cvt_pk_bf16_f32 v43, 0, v43
  v_cvt_pk_bf16_f32 v44, 0, v44
  v_cvt_pk_bf16_f32 v45, 0, v45
  v_cvt_pk_bf16_f32 v46, 0, v46
  v_cvt_pk_bf16_f32 v47, 0, v47
  v_mul_f32 v40, v40, v100
  v_mul_f32 v41, v41, v101
  v_mul_f32 v42, v42, v102
  v_mul_f32 v43, v43, v103
  v_mul_f32 v44, v44, v112
  v_mul_f32 v45, v45, v113
  v_mul_f32 v46, v46, v114
  v_mul_f32 v47, v47, v115
  v_cvt_pk_bf16_f32 v40, 0, v40
  v_cvt_pk_bf16_f32 v41, 0, v41
  v_cvt_pk_bf16_f32 v42, 0, v42
  v_cvt_pk_bf16_f32 v43, 0, v43
  v_cvt_pk_bf16_f32 v44, 0, v44
  v_cvt_pk_bf16_f32 v45, 0, v45
  v_cvt_pk_bf16_f32 v46, 0, v46
  v_cvt_pk_bf16_f32 v47, 0, v47
  v_mul_f32 v40, v40, v104
  v_mul_f32 v41, v41, v105
  v_mul_f32 v42, v42, v106
  v_mul_f32 v43, v43, v107
  v_mul_f32 v44, v44, v116
  v_mul_f32 v45, v45, v117
  v_mul_f32 v46, v46, v118
  v_mul_f32 v47, v47, v119
  v_cvt_pk_bf16_f32 v124, v40, v41
  v_cvt_pk_bf16_f32 v125, v42, v43
  v_cvt_pk_bf16_f32 v126, v44, v45
  v_cvt_pk_bf16_f32 v127, v46, v47
  ds_write_b64 v14, v[124:125] offset:512
  ds_write_b64 v14, v[126:127] offset:1024
  s_waitcnt lgkmcnt(0)
  s_barrier
  ds_read_b128 v[32:35], v12 offset:3072
  ds_read_b128 v[36:39], v12 offset:4096
  s_waitcnt lgkmcnt(1)
  v_mfma_f32_16x16x32_bf16 v[32:35], a[48:51], v[64:67], v[32:35]
  ds_read_b64 v[120:121], v9 offset:2048
  ds_read_b64 v[122:123], v10 offset:2048
  ds_read_b128 v[104:107], v11 offset:3072
  s_waitcnt lgkmcnt(3)
  v_mfma_f32_16x16x32_bf16 v[36:39], a[64:67], v[64:67], v[36:39]
  ds_read_b128 v[64:67], v8 offset:2688
  v_mfma_f32_16x16x32_bf16 v[32:35], a[32:35], v[68:71], v[32:35]
  v_mfma_f32_16x16x32_bf16 v[36:39], a[48:51], v[68:71], v[36:39]
  ds_read_b128 v[68:71], v8 offset:2176
  v_mfma_f32_16x16x32_bf16 v[32:35], a[16:19], v[72:75], v[32:35]
  v_mfma_f32_16x16x32_bf16 v[36:39], a[32:35], v[72:75], v[36:39]
  s_waitcnt lgkmcnt(2)
  v_lshlrev_b32 v99, 16, v120
  v_and_b32 v98, v27, v120
  ds_read_b128 v[72:75], v8 offset:1664
  v_mfma_f32_16x16x32_bf16 v[32:35], a[0:3], v[76:79], v[32:35]
  v_lshlrev_b32 v97, 16, v121
  v_and_b32 v96, v27, v121
  v_mfma_f32_16x16x32_bf16 v[36:39], a[16:19], v[76:79], v[36:39]
  v_perm_b32 v103, v122, v24, v22
  v_perm_b32 v102, v122, v24, v23
  ds_read_b128 v[76:79], v8 offset:3776
  v_mfma_f32_16x16x32_bf16 v[36:39], a[0:3], v[80:83], v[36:39]
  v_perm_b32 v101, v123, v24, v22
  v_perm_b32 v100, v123, v24, v23
  ds_read_b128 v[80:83], v8 offset:3264
  v_mfma_f32_16x16x32_bf16 v[32:35], a[52:55], v[84:87], v[32:35]
  v_mul_f32 v96, v26, v96
  v_mul_f32 v97, v26, v97
  v_mfma_f32_16x16x32_bf16 v[36:39], a[68:71], v[84:87], v[36:39]
  v_mul_f32 v98, v26, v98
  v_mul_f32 v99, v26, v99
  ds_read_b128 v[84:87], v8 offset:2752
  v_mfma_f32_16x16x32_bf16 v[32:35], a[36:39], v[88:91], v[32:35]
  v_perm_b32 v104, v104, v104, v25
  v_perm_b32 v105, v105, v105, v25
  v_mfma_f32_16x16x32_bf16 v[36:39], a[52:55], v[88:91], v[36:39]
  v_perm_b32 v106, v106, v106, v25
  v_perm_b32 v107, v107, v107, v25
  ds_read_b128 v[88:91], v8 offset:2240
  v_mfma_f32_16x16x32_bf16 v[32:35], a[20:23], v[92:95], v[32:35]
  v_cvt_pk_bf16_f32 v96, 0, v96
  v_cvt_pk_bf16_f32 v97, 0, v97
  v_mfma_f32_16x16x32_bf16 v[36:39], a[36:39], v[92:95], v[36:39]
  v_cvt_pk_bf16_f32 v98, 0, v98
  v_cvt_pk_bf16_f32 v99, 0, v99
  ds_read_b64 v[120:121], v9 offset:1536
  ds_read_b64 v[122:123], v10 offset:1536
  ds_read_b128 v[116:119], v11 offset:4096
  ds_read_b128 v[92:95], v8 offset:1728
  v_mfma_f32_16x16x32_bf16 v[32:35], a[4:7], v[48:51], v[32:35]
  v_mfma_f32_16x16x32_bf16 v[36:39], a[20:23], v[48:51], v[36:39]
  ds_read_b128 v[48:51], v8 offset:3584
  v_mfma_f32_16x16x32_bf16 v[36:39], a[4:7], v[52:55], v[36:39]
  ds_read_b128 v[52:55], v8 offset:3072
  v_mfma_f32_16x16x32_bf16 v[32:35], a[56:59], v[56:59], v[32:35]
  v_mfma_f32_16x16x32_bf16 v[36:39], a[72:75], v[56:59], v[36:39]
  s_waitcnt lgkmcnt(3)
  v_lshlrev_b32 v111, 16, v120
  v_and_b32 v110, v27, v120
  ds_read_b128 v[56:59], v8 offset:2560
  v_mfma_f32_16x16x32_bf16 v[32:35], a[40:43], v[60:63], v[32:35]
  v_lshlrev_b32 v109, 16, v121
  v_and_b32 v108, v27, v121
  v_mfma_f32_16x16x32_bf16 v[36:39], a[56:59], v[60:63], v[36:39]
  v_perm_b32 v115, v122, v24, v22
  v_perm_b32 v114, v122, v24, v23
  ds_read_b128 v[60:63], v8 offset:2048
  v_mfma_f32_16x16x32_bf16 v[32:35], a[24:27], v[64:67], v[32:35]
  v_perm_b32 v113, v123, v24, v22
  v_perm_b32 v112, v123, v24, v23
  v_mfma_f32_16x16x32_bf16 v[36:39], a[40:43], v[64:67], v[36:39]
  v_mul_f32 v108, v26, v108
  v_mul_f32 v109, v26, v109
  ds_read_b128 v[64:67], v8 offset:1536
  v_mfma_f32_16x16x32_bf16 v[32:35], a[8:11], v[68:71], v[32:35]
  v_mul_f32 v110, v26, v110
  v_mul_f32 v111, v26, v111
  v_mfma_f32_16x16x32_bf16 v[36:39], a[24:27], v[68:71], v[36:39]
  v_perm_b32 v116, v116, v116, v25
  v_perm_b32 v117, v117, v117, v25
  ds_read_b128 v[68:71], v8 offset:1024
  v_mfma_f32_16x16x32_bf16 v[36:39], a[8:11], v[72:75], v[36:39]
  v_perm_b32 v118, v118, v118, v25
  v_perm_b32 v119, v119, v119, v25
  ds_read_b128 v[72:75], v8 offset:512
  v_mfma_f32_16x16x32_bf16 v[32:35], a[60:63], v[76:79], v[32:35]
  v_cvt_pk_bf16_f32 v108, 0, v108
  v_cvt_pk_bf16_f32 v109, 0, v109
  v_mfma_f32_16x16x32_bf16 v[36:39], a[76:79], v[76:79], v[36:39]
  v_cvt_pk_bf16_f32 v110, 0, v110
  v_cvt_pk_bf16_f32 v111, 0, v111
  ds_read_b128 v[76:79], v8 offset:3648
  v_mfma_f32_16x16x32_bf16 v[32:35], a[44:47], v[80:83], v[32:35]
  v_mfma_f32_16x16x32_bf16 v[36:39], a[60:63], v[80:83], v[36:39]
  ds_read_b128 v[80:83], v8 offset:3136
  s_waitcnt lgkmcnt(9)
  v_mfma_f32_16x16x32_bf16 v[32:35], a[28:31], v[84:87], v[32:35]
  v_mfma_f32_16x16x32_bf16 v[36:39], a[44:47], v[84:87], v[36:39]
  ds_read_b128 v[84:87], v8 offset:2624
  v_mfma_f32_16x16x32_bf16 v[32:35], a[12:15], v[88:91], v[32:35]
  v_mfma_f32_16x16x32_bf16 v[36:39], a[28:31], v[88:91], v[36:39]
  ds_read_b128 v[88:91], v8 offset:2112
  v_mfma_f32_16x16x32_bf16 v[36:39], a[12:15], v[92:95], v[36:39]
  ds_read_b128 v[92:95], v8 offset:1600
  s_nop 3
  v_cvt_pk_bf16_f32 v32, 0, v32
  v_cvt_pk_bf16_f32 v33, 0, v33
  v_cvt_pk_bf16_f32 v34, 0, v34
  v_cvt_pk_bf16_f32 v35, 0, v35
  v_cvt_pk_bf16_f32 v36, 0, v36
  v_cvt_pk_bf16_f32 v37, 0, v37
  v_cvt_pk_bf16_f32 v38, 0, v38
  v_cvt_pk_bf16_f32 v39, 0, v39
  v_add_f32 v32, v32, v96
  v_add_f32 v33, v33, v97
  v_add_f32 v34, v34, v98
  v_add_f32 v35, v35, v99
  v_add_f32 v36, v36, v108
  v_add_f32 v37, v37, v109
  v_add_f32 v38, v38, v110
  v_add_f32 v39, v39, v111
  v_cvt_pk_bf16_f32 v32, 0, v32
  v_cvt_pk_bf16_f32 v33, 0, v33
  v_cvt_pk_bf16_f32 v34, 0, v34
  v_cvt_pk_bf16_f32 v35, 0, v35
  v_cvt_pk_bf16_f32 v36, 0, v36
  v_cvt_pk_bf16_f32 v37, 0, v37
  v_cvt_pk_bf16_f32 v38, 0, v38
  v_cvt_pk_bf16_f32 v39, 0, v39
  v_mul_f32 v32, v32, v100
  v_mul_f32 v33, v33, v101
  v_mul_f32 v34, v34, v102
  v_mul_f32 v35, v35, v103
  v_mul_f32 v36, v36, v112
  v_mul_f32 v37, v37, v113
  v_mul_f32 v38, v38, v114
  v_mul_f32 v39, v39, v115
  v_cvt_pk_bf16_f32 v32, 0, v32
  v_cvt_pk_bf16_f32 v33, 0, v33
  v_cvt_pk_bf16_f32 v34, 0, v34
  v_cvt_pk_bf16_f32 v35, 0, v35
  v_cvt_pk_bf16_f32 v36, 0, v36
  v_cvt_pk_bf16_f32 v37, 0, v37
  v_cvt_pk_bf16_f32 v38, 0, v38
  v_cvt_pk_bf16_f32 v39, 0, v39
  v_mul_f32 v32, v32, v104
  v_mul_f32 v33, v33, v105
  v_mul_f32 v34, v34, v106
  v_mul_f32 v35, v35, v107
  v_mul_f32 v36, v36, v116
  v_mul_f32 v37, v37, v117
  v_mul_f32 v38, v38, v118
  v_mul_f32 v39, v39, v119
  v_cvt_pk_bf16_f32 v124, v32, v33
  v_cvt_pk_bf16_f32 v125, v34, v35
  v_cvt_pk_bf16_f32 v126, v36, v37
  v_cvt_pk_bf16_f32 v127, v38, v39
  ds_write_b64 v14, v[124:125] offset:1536
  ds_write_b64 v14, v[126:127] offset:2048
  s_waitcnt lgkmcnt(0)
  s_barrier
  ds_read_b128 v[40:43], v12 offset:5120
  ds_read_b128 v[44:47], v12 offset:6144
  s_waitcnt lgkmcnt(1)
  v_mfma_f32_16x16x32_bf16 v[40:43], a[80:83], v[48:51], v[40:43]
  ds_read_b64 v[120:121], v9 offset:1024
  ds_read_b64 v[122:123], v10 offset:1024
  ds_read_b128 v[104:107], v11 offset:5120
  s_waitcnt lgkmcnt(3)
  v_mfma_f32_16x16x32_bf16 v[44:47], a[96:99], v[48:51], v[44:47]
  ds_read_b128 v[48:51], v8 offset:1088
  v_mfma_f32_16x16x32_bf16 v[40:43], a[64:67], v[52:55], v[40:43]
  v_mfma_f32_16x16x32_bf16 v[44:47], a[80:83], v[52:55], v[44:47]
  ds_read_b128 v[52:55], v8 offset:576
  v_mfma_f32_16x16x32_bf16 v[40:43], a[48:51], v[56:59], v[40:43]
  v_mfma_f32_16x16x32_bf16 v[44:47], a[64:67], v[56:59], v[44:47]
  s_waitcnt lgkmcnt(2)
  v_lshlrev_b32 v99, 16, v120
  v_and_b32 v98, v27, v120
  ds_read_b128 v[56:59], v8 offset:3712
  v_mfma_f32_16x16x32_bf16 v[40:43], a[32:35], v[60:63], v[40:43]
  v_lshlrev_b32 v97, 16, v121
  v_and_b32 v96, v27, v121
  v_mfma_f32_16x16x32_bf16 v[44:47], a[48:51], v[60:63], v[44:47]
  v_perm_b32 v103, v122, v24, v22
  v_perm_b32 v102, v122, v24, v23
  ds_read_b128 v[60:63], v8 offset:3200
  v_mfma_f32_16x16x32_bf16 v[40:43], a[16:19], v[64:67], v[40:43]
  v_perm_b32 v101, v123, v24, v22
  v_perm_b32 v100, v123, v24, v23
  v_mfma_f32_16x16x32_bf16 v[44:47], a[32:35], v[64:67], v[44:47]
  v_mul_f32 v96, v26, v96
  v_mul_f32 v97, v26, v97
  ds_read_b128 v[64:67], v8 offset:2688
  v_mfma_f32_16x16x32_bf16 v[40:43], a[0:3], v[68:71], v[40:43]
  v_mul_f32 v98, v26, v98
  v_mul_f32 v99, v26, v99
  v_mfma_f32_16x16x32_bf16 v[44:47], a[16:19], v[68:71], v[44:47]
  v_perm_b32 v104, v104, v104, v25
  v_perm_b32 v105, v105, v105, v25
  ds_read_b128 v[68:71], v8 offset:2176
  v_mfma_f32_16x16x32_bf16 v[44:47], a[0:3], v[72:75], v[44:47]
  v_perm_b32 v106, v106, v106, v25
  v_perm_b32 v107, v107, v107, v25
  ds_read_b128 v[72:75], v8 offset:1664
  v_mfma_f32_16x16x32_bf16 v[40:43], a[84:87], v[76:79], v[40:43]
  v_cvt_pk_bf16_f32 v96, 0, v96
  v_cvt_pk_bf16_f32 v97, 0, v97
  v_mfma_f32_16x16x32_bf16 v[44:47], a[100:103], v[76:79], v[44:47]
  v_cvt_pk_bf16_f32 v98, 0, v98
  v_cvt_pk_bf16_f32 v99, 0, v99
  ds_read_b64 v[120:121], v9 offset:512
  ds_read_b64 v[122:123], v10 offset:512
  ds_read_b128 v[116:119], v11 offset:6144
  ds_read_b128 v[76:79], v8 offset:1152
  v_mfma_f32_16x16x32_bf16 v[40:43], a[68:71], v[80:83], v[40:43]
  v_mfma_f32_16x16x32_bf16 v[44:47], a[84:87], v[80:83], v[44:47]
  ds_read_b128 v[80:83], v8 offset:640
  v_mfma_f32_16x16x32_bf16 v[40:43], a[52:55], v[84:87], v[40:43]
  v_mfma_f32_16x16x32_bf16 v[44:47], a[68:71], v[84:87], v[44:47]
  ds_read_b128 v[84:87], v8 offset:3776
  v_mfma_f32_16x16x32_bf16 v[40:43], a[36:39], v[88:91], v[40:43]
  s_waitcnt lgkmcnt(3)
  v_lshlrev_b32 v111, 16, v120
  v_and_b32 v110, v27, v120
  v_mfma_f32_16x16x32_bf16 v[44:47], a[52:55], v[88:91], v[44:47]
  v_lshlrev_b32 v109, 16, v121
  v_and_b32 v108, v27, v121
  ds_read_b128 v[88:91], v8 offset:3264
  v_mfma_f32_16x16x32_bf16 v[40:43], a[20:23], v[92:95], v[40:43]
  v_perm_b32 v115, v122, v24, v22
  v_perm_b32 v114, v122, v24, v23
  v_mfma_f32_16x16x32_bf16 v[44:47], a[36:39], v[92:95], v[44:47]
  v_perm_b32 v113, v123, v24, v22
  v_perm_b32 v112, v123, v24, v23
  ds_read_b128 v[92:95], v8 offset:2752
  v_mfma_f32_16x16x32_bf16 v[40:43], a[4:7], v[48:51], v[40:43]
  v_mul_f32 v108, v26, v108
  v_mul_f32 v109, v26, v109
  v_mfma_f32_16x16x32_bf16 v[44:47], a[20:23], v[48:51], v[44:47]
  v_mul_f32 v110, v26, v110
  v_mul_f32 v111, v26, v111
  ds_read_b128 v[48:51], v8 offset:2240
  v_mfma_f32_16x16x32_bf16 v[44:47], a[4:7], v[52:55], v[44:47]
  v_perm_b32 v116, v116, v116, v25
  v_perm_b32 v117, v117, v117, v25
  ds_read_b128 v[52:55], v8 offset:1728
  v_mfma_f32_16x16x32_bf16 v[40:43], a[88:91], v[56:59], v[40:43]
  v_perm_b32 v118, v118, v118, v25
  v_perm_b32 v119, v119, v119, v25
  v_mfma_f32_16x16x32_bf16 v[44:47], a[104:107], v[56:59], v[44:47]
  v_cvt_pk_bf16_f32 v108, 0, v108
  v_cvt_pk_bf16_f32 v109, 0, v109
  ds_read_b128 v[56:59], v8 offset:1216
  v_mfma_f32_16x16x32_bf16 v[40:43], a[72:75], v[60:63], v[40:43]
  v_cvt_pk_bf16_f32 v110, 0, v110
  v_cvt_pk_bf16_f32 v111, 0, v111
  v_mfma_f32_16x16x32_bf16 v[44:47], a[88:91], v[60:63], v[44:47]
  ds_read_b128 v[60:63], v8 offset:704
  v_mfma_f32_16x16x32_bf16 v[40:43], a[56:59], v[64:67], v[40:43]
  v_mfma_f32_16x16x32_bf16 v[44:47], a[72:75], v[64:67], v[44:47]
  ds_read_b128 v[64:67], v8 offset:3584
  v_mfma_f32_16x16x32_bf16 v[40:43], a[40:43], v[68:71], v[40:43]
  v_mfma_f32_16x16x32_bf16 v[44:47], a[56:59], v[68:71], v[44:47]
  ds_read_b128 v[68:71], v8 offset:3072
  s_waitcnt lgkmcnt(9)
  v_mfma_f32_16x16x32_bf16 v[40:43], a[24:27], v[72:75], v[40:43]
  v_mfma_f32_16x16x32_bf16 v[44:47], a[40:43], v[72:75], v[44:47]
  ds_read_b128 v[72:75], v8 offset:2560
  v_mfma_f32_16x16x32_bf16 v[40:43], a[8:11], v[76:79], v[40:43]
  v_mfma_f32_16x16x32_bf16 v[44:47], a[24:27], v[76:79], v[44:47]
  ds_read_b128 v[76:79], v8 offset:2048
  v_mfma_f32_16x16x32_bf16 v[44:47], a[8:11], v[80:83], v[44:47]
  ds_read_b128 v[80:83], v8 offset:1536
  s_waitcnt lgkmcnt(9)
  v_mfma_f32_16x16x32_bf16 v[40:43], a[92:95], v[84:87], v[40:43]
  v_mfma_f32_16x16x32_bf16 v[44:47], a[108:111], v[84:87], v[44:47]
  ds_read_b128 v[84:87], v8 offset:1024
  v_mfma_f32_16x16x32_bf16 v[40:43], a[76:79], v[88:91], v[40:43]
  v_mfma_f32_16x16x32_bf16 v[44:47], a[92:95], v[88:91], v[44:47]
  ds_read_b128 v[88:91], v8 offset:512
  v_mfma_f32_16x16x32_bf16 v[40:43], a[60:63], v[92:95], v[40:43]
  v_mfma_f32_16x16x32_bf16 v[44:47], a[76:79], v[92:95], v[44:47]
  ds_read_b128 v[92:95], v8 offset:0
  s_waitcnt lgkmcnt(9)
  v_mfma_f32_16x16x32_bf16 v[40:43], a[44:47], v[48:51], v[40:43]
  v_mfma_f32_16x16x32_bf16 v[44:47], a[60:63], v[48:51], v[44:47]
  ds_read_b128 v[48:51], v8 offset:3648
  v_mfma_f32_16x16x32_bf16 v[40:43], a[28:31], v[52:55], v[40:43]
  v_mfma_f32_16x16x32_bf16 v[44:47], a[44:47], v[52:55], v[44:47]
  ds_read_b128 v[52:55], v8 offset:3136
  v_mfma_f32_16x16x32_bf16 v[40:43], a[12:15], v[56:59], v[40:43]
  v_mfma_f32_16x16x32_bf16 v[44:47], a[28:31], v[56:59], v[44:47]
  ds_read_b128 v[56:59], v8 offset:2624
  s_waitcnt lgkmcnt(9)
  v_mfma_f32_16x16x32_bf16 v[44:47], a[12:15], v[60:63], v[44:47]
  ds_read_b128 v[60:63], v8 offset:2112
  s_nop 2
  v_cvt_pk_bf16_f32 v40, 0, v40
  v_cvt_pk_bf16_f32 v41, 0, v41
  v_cvt_pk_bf16_f32 v42, 0, v42
  v_cvt_pk_bf16_f32 v43, 0, v43
  v_cvt_pk_bf16_f32 v44, 0, v44
  v_cvt_pk_bf16_f32 v45, 0, v45
  v_cvt_pk_bf16_f32 v46, 0, v46
  v_cvt_pk_bf16_f32 v47, 0, v47
  v_add_f32 v40, v40, v96
  v_add_f32 v41, v41, v97
  v_add_f32 v42, v42, v98
  v_add_f32 v43, v43, v99
  v_add_f32 v44, v44, v108
  v_add_f32 v45, v45, v109
  v_add_f32 v46, v46, v110
  v_add_f32 v47, v47, v111
  v_cvt_pk_bf16_f32 v40, 0, v40
  v_cvt_pk_bf16_f32 v41, 0, v41
  v_cvt_pk_bf16_f32 v42, 0, v42
  v_cvt_pk_bf16_f32 v43, 0, v43
  v_cvt_pk_bf16_f32 v44, 0, v44
  v_cvt_pk_bf16_f32 v45, 0, v45
  v_cvt_pk_bf16_f32 v46, 0, v46
  v_cvt_pk_bf16_f32 v47, 0, v47
  v_mul_f32 v40, v40, v100
  v_mul_f32 v41, v41, v101
  v_mul_f32 v42, v42, v102
  v_mul_f32 v43, v43, v103
  v_mul_f32 v44, v44, v112
  v_mul_f32 v45, v45, v113
  v_mul_f32 v46, v46, v114
  v_mul_f32 v47, v47, v115
  v_cvt_pk_bf16_f32 v40, 0, v40
  v_cvt_pk_bf16_f32 v41, 0, v41
  v_cvt_pk_bf16_f32 v42, 0, v42
  v_cvt_pk_bf16_f32 v43, 0, v43
  v_cvt_pk_bf16_f32 v44, 0, v44
  v_cvt_pk_bf16_f32 v45, 0, v45
  v_cvt_pk_bf16_f32 v46, 0, v46
  v_cvt_pk_bf16_f32 v47, 0, v47
  v_mul_f32 v40, v40, v104
  v_mul_f32 v41, v41, v105
  v_mul_f32 v42, v42, v106
  v_mul_f32 v43, v43, v107
  v_mul_f32 v44, v44, v116
  v_mul_f32 v45, v45, v117
  v_mul_f32 v46, v46, v118
  v_mul_f32 v47, v47, v119
  v_cvt_pk_bf16_f32 v124, v40, v41
  v_cvt_pk_bf16_f32 v125, v42, v43
  v_cvt_pk_bf16_f32 v126, v44, v45
  v_cvt_pk_bf16_f32 v127, v46, v47
  ds_write_b64 v14, v[124:125] offset:2560
  ds_write_b64 v14, v[126:127] offset:3072
  s_waitcnt lgkmcnt(0)
  s_barrier
  ds_read_b128 v[32:35], v12 offset:7168
  s_waitcnt lgkmcnt(0)
  v_mfma_f32_16x16x32_bf16 v[32:35], a[112:115], v[64:67], v[32:35]
  ds_read_b64 v[120:121], v9 offset:0
  ds_read_b64 v[122:123], v10 offset:0
  ds_read_b128 v[104:107], v11 offset:7168
  ds_read_b128 v[64:67], v8 offset:1600
  v_mfma_f32_16x16x32_bf16 v[32:35], a[96:99], v[68:71], v[32:35]
  ds_read_b128 v[68:71], v8 offset:1088
  v_mfma_f32_16x16x32_bf16 v[32:35], a[80:83], v[72:75], v[32:35]
  ds_read_b128 v[72:75], v8 offset:576
  v_mfma_f32_16x16x32_bf16 v[32:35], a[64:67], v[76:79], v[32:35]
  ds_read_b128 v[76:79], v8 offset:64
  v_mfma_f32_16x16x32_bf16 v[32:35], a[48:51], v[80:83], v[32:35]
  ds_read_b128 v[80:83], v8 offset:3712
  v_mfma_f32_16x16x32_bf16 v[32:35], a[32:35], v[84:87], v[32:35]
  s_waitcnt lgkmcnt(5)
  v_lshlrev_b32 v99, 16, v120
  v_and_b32 v98, v27, v120
  ds_read_b128 v[84:87], v8 offset:3200
  v_mfma_f32_16x16x32_bf16 v[32:35], a[16:19], v[88:91], v[32:35]
  v_lshlrev_b32 v97, 16, v121
  v_and_b32 v96, v27, v121
  ds_read_b128 v[88:91], v8 offset:2688
  v_mfma_f32_16x16x32_bf16 v[32:35], a[0:3], v[92:95], v[32:35]
  v_perm_b32 v103, v122, v24, v22
  v_perm_b32 v102, v122, v24, v23
  ds_read_b128 v[92:95], v8 offset:2176
  v_mfma_f32_16x16x32_bf16 v[32:35], a[116:119], v[48:51], v[32:35]
  v_perm_b32 v101, v123, v24, v22
  v_perm_b32 v100, v123, v24, v23
  ds_read_b128 v[48:51], v8 offset:1664
  v_mfma_f32_16x16x32_bf16 v[32:35], a[100:103], v[52:55], v[32:35]
  v_mul_f32 v96, v26, v96
  v_mul_f32 v97, v26, v97
  ds_read_b128 v[52:55], v8 offset:1152
  v_mfma_f32_16x16x32_bf16 v[32:35], a[84:87], v[56:59], v[32:35]
  v_mul_f32 v98, v26, v98
  v_mul_f32 v99, v26, v99
  ds_read_b128 v[56:59], v8 offset:640
  s_waitcnt lgkmcnt(9)
  v_mfma_f32_16x16x32_bf16 v[32:35], a[68:71], v[60:63], v[32:35]
  v_perm_b32 v104, v104, v104, v25
  v_perm_b32 v105, v105, v105, v25
  ds_read_b128 v[60:63], v8 offset:128
  v_mfma_f32_16x16x32_bf16 v[32:35], a[52:55], v[64:67], v[32:35]
  v_perm_b32 v106, v106, v106, v25
  v_perm_b32 v107, v107, v107, v25
  ds_read_b128 v[64:67], v8 offset:3776
  v_mfma_f32_16x16x32_bf16 v[32:35], a[36:39], v[68:71], v[32:35]
  v_cvt_pk_bf16_f32 v96, 0, v96
  v_cvt_pk_bf16_f32 v97, 0, v97
  ds_read_b128 v[68:71], v8 offset:3264
  s_waitcnt lgkmcnt(9)
  v_mfma_f32_16x16x32_bf16 v[32:35], a[20:23], v[72:75], v[32:35]
  v_cvt_pk_bf16_f32 v98, 0, v98
  v_cvt_pk_bf16_f32 v99, 0, v99
  ds_read_b128 v[72:75], v8 offset:2752
  v_mfma_f32_16x16x32_bf16 v[32:35], a[4:7], v[76:79], v[32:35]
  ds_read_b128 v[76:79], v8 offset:2240
  v_mfma_f32_16x16x32_bf16 v[32:35], a[120:123], v[80:83], v[32:35]
  ds_read_b128 v[80:83], v8 offset:1728
  s_waitcnt lgkmcnt(9)
  v_mfma_f32_16x16x32_bf16 v[32:35], a[104:107], v[84:87], v[32:35]
  ds_read_b128 v[84:87], v8 offset:1216
  v_mfma_f32_16x16x32_bf16 v[32:35], a[88:91], v[88:91], v[32:35]
  ds_read_b128 v[88:91], v8 offset:704
  v_mfma_f32_16x16x32_bf16 v[32:35], a[72:75], v[92:95], v[32:35]
  ds_read_b128 v[92:95], v8 offset:192
  s_waitcnt lgkmcnt(9)
  v_mfma_f32_16x16x32_bf16 v[32:35], a[56:59], v[48:51], v[32:35]
  v_mfma_f32_16x16x32_bf16 v[32:35], a[40:43], v[52:55], v[32:35]
  v_mfma_f32_16x16x32_bf16 v[32:35], a[24:27], v[56:59], v[32:35]
  s_waitcnt lgkmcnt(6)
  v_mfma_f32_16x16x32_bf16 v[32:35], a[8:11], v[60:63], v[32:35]
  v_mfma_f32_16x16x32_bf16 v[32:35], a[124:127], v[64:67], v[32:35]
  v_mfma_f32_16x16x32_bf16 v[32:35], a[108:111], v[68:71], v[32:35]
  s_waitcnt lgkmcnt(3)
  v_mfma_f32_16x16x32_bf16 v[32:35], a[92:95], v[72:75], v[32:35]
  v_mfma_f32_16x16x32_bf16 v[32:35], a[76:79], v[76:79], v[32:35]
  v_mfma_f32_16x16x32_bf16 v[32:35], a[60:63], v[80:83], v[32:35]
  s_waitcnt lgkmcnt(0)
  v_mfma_f32_16x16x32_bf16 v[32:35], a[44:47], v[84:87], v[32:35]
  v_mfma_f32_16x16x32_bf16 v[32:35], a[28:31], v[88:91], v[32:35]
  v_mfma_f32_16x16x32_bf16 v[32:35], a[12:15], v[92:95], v[32:35]
  s_nop 7
  v_cvt_pk_bf16_f32 v32, 0, v32
  v_cvt_pk_bf16_f32 v33, 0, v33
  v_cvt_pk_bf16_f32 v34, 0, v34
  v_cvt_pk_bf16_f32 v35, 0, v35
  v_add_f32 v32, v32, v96
  v_add_f32 v33, v33, v97
  v_add_f32 v34, v34, v98
  v_add_f32 v35, v35, v99
  v_cvt_pk_bf16_f32 v32, 0, v32
  v_cvt_pk_bf16_f32 v33, 0, v33
  v_cvt_pk_bf16_f32 v34, 0, v34
  v_cvt_pk_bf16_f32 v35, 0, v35
  v_mul_f32 v32, v32, v100
  v_mul_f32 v33, v33, v101
  v_mul_f32 v34, v34, v102
  v_mul_f32 v35, v35, v103
  v_cvt_pk_bf16_f32 v32, 0, v32
  v_cvt_pk_bf16_f32 v33, 0, v33
  v_cvt_pk_bf16_f32 v34, 0, v34
  v_cvt_pk_bf16_f32 v35, 0, v35
  v_mul_f32 v32, v32, v104
  v_mul_f32 v33, v33, v105
  v_mul_f32 v34, v34, v106
  v_mul_f32 v35, v35, v107
  v_cvt_pk_bf16_f32 v124, v32, v33
  v_cvt_pk_bf16_f32 v125, v34, v35
  ds_write_b64 v14, v[124:125] offset:3584
  s_waitcnt lgkmcnt(0)
  s_barrier
  s_endpgm
L_H1:
  v_mov_b32 v27, 0xffff0000
  ds_read_b128 v[48:51], v8 offset:3584
  ds_read_b128 v[52:55], v8 offset:3648
  ds_read_b128 v[56:59], v8 offset:3712
  ds_read_b128 v[60:63], v8 offset:3776
  ds_read_b128 v[64:67], v8 offset:3584
  ds_read_b128 v[68:71], v8 offset:3072
  ds_read_b128 v[72:75], v8 offset:2560
  ds_read_b128 v[76:79], v8 offset:3648
  ds_read_b128 v[80:83], v8 offset:3136
  ds_read_b128 v[84:87], v8 offset:2624
  ds_read_b128 v[88:91], v8 offset:3712
  ds_read_b128 v[92:95], v8 offset:3200
  ds_read_b128 v[96:99], v8 offset:2688
  ds_read_b128 v[100:103], v8 offset:3776
  ds_read_b128 v[104:107], v8 offset:3264
  ds_read_b128 v[108:111], v8 offset:2752
  s_waitcnt lgkmcnt(13)
  v_mfma_f32_16x16x32_bf16 v[32:35], a[0:3], v[48:51], 0
  ds_read_b128 v[48:51], v8 offset:3584
  v_mfma_f32_16x16x32_bf16 v[32:35], a[4:7], v[52:55], v[32:35]
  ds_read_b128 v[52:55], v8 offset:3072
  v_mfma_f32_16x16x32_bf16 v[32:35], a[8:11], v[56:59], v[32:35]
  ds_read_b128 v[56:59], v8 offset:2560
  s_waitcnt lgkmcnt(13)
  v_mfma_f32_16x16x32_bf16 v[32:35], a[12:15], v[60:63], v[32:35]
  s_nop 7
  ds_write_b128 v12, v[32:35] offset:0
  ds_read_b128 v[60:63], v8 offset:2048
  s_waitcnt lgkmcnt(1)
  s_waitcnt vmcnt(0)
  s_barrier
  v_mfma_f32_16x16x32_bf16 v[40:43], a[16:19], v[64:67], 0
  v_mfma_f32_16x16x32_bf16 v[44:47], a[32:35], v[64:67], 0
  ds_read_b128 v[64:67], v8 offset:1536
  v_mfma_f32_16x16x32_bf16 v[40:43], a[0:3], v[68:71], v[40:43]
  v_mfma_f32_16x16x32_bf16 v[44:47], a[16:19], v[68:71], v[44:47]
  ds_read_b128 v[68:71], v8 offset:3648
  v_mfma_f32_16x16x32_bf16 v[44:47], a[0:3], v[72:75], v[44:47]
  ds_read_b128 v[72:75], v8 offset:3136
  v_mfma_f32_16x16x32_bf16 v[40:43], a[20:23], v[76:79], v[40:43]
  v_mfma_f32_16x16x32_bf16 v[44:47], a[36:39], v[76:79], v[44:47]
  ds_read_b128 v[76:79], v8 offset:2624
  v_mfma_f32_16x16x32_bf16 v[40:43], a[4:7], v[80:83], v[40:43]
  v_mfma_f32_16x16x32_bf16 v[44:47], a[20:23], v[80:83], v[44:47]
  ds_read_b128 v[80:83], v8 offset:2112
  v_mfma_f32_16x16x32_bf16 v[44:47], a[4:7], v[84:87], v[44:47]
  ds_read_b128 v[84:87], v8 offset:1600
  v_mfma_f32_16x16x32_bf16 v[40:43], a[24:27], v[88:91], v[40:43]
  v_mfma_f32_16x16x32_bf16 v[44:47], a[40:43], v[88:91], v[44:47]
  ds_read_b128 v[88:91], v8 offset:3712
  v_mfma_f32_16x16x32_bf16 v[40:43], a[8:11], v[92:95], v[40:43]
  v_mfma_f32_16x16x32_bf16 v[44:47], a[24:27], v[92:95], v[44:47]
  ds_read_b128 v[92:95], v8 offset:3200
  v_mfma_f32_16x16x32_bf16 v[44:47], a[8:11], v[96:99], v[44:47]
  ds_read_b128 v[96:99], v8 offset:2688
  v_mfma_f32_16x16x32_bf16 v[40:43], a[28:31], v[100:103], v[40:43]
  v_mfma_f32_16x16x32_bf16 v[44:47], a[44:47], v[100:103], v[44:47]
  ds_read_b128 v[100:103], v8 offset:2176
  v_mfma_f32_16x16x32_bf16 v[40:43], a[12:15], v[104:107], v[40:43]
  v_mfma_f32_16x16x32_bf16 v[44:47], a[28:31], v[104:107], v[44:47]
  ds_read_b128 v[104:107], v8 offset:1664
  v_mfma_f32_16x16x32_bf16 v[44:47], a[12:15], v[108:111], v[44:47]
  s_nop 4
  ds_write_b128 v12, v[40:43] offset:1024
  s_nop 1
  ds_write_b128 v12, v[44:47] offset:2048
  ds_read_b128 v[108:111], v8 offset:3776
  s_waitcnt lgkmcnt(1)
  s_barrier
  v_mfma_f32_16x16x32_bf16 v[32:35], a[48:51], v[48:51], 0
  ds_read_u16_d16_hi v112, v15 offset:0
  ds_read_u16_d16_hi v113, v15 offset:4096
  ds_read_u16_d16_hi v114, v15 offset:8192
  ds_read_u16_d16_hi v115, v15 offset:12288
  v_mfma_f32_16x16x32_bf16 v[36:39], a[64:67], v[48:51], 0
  ds_read_b128 v[48:51], v8 offset:3264
  v_mfma_f32_16x16x32_bf16 v[32:35], a[32:35], v[52:55], v[32:35]
  v_mfma_f32_16x16x32_bf16 v[36:39], a[48:51], v[52:55], v[36:39]
  ds_read_b128 v[52:55], v8 offset:2752
  v_mfma_f32_16x16x32_bf16 v[32:35], a[16:19], v[56:59], v[32:35]
  v_mfma_f32_16x16x32_bf16 v[36:39], a[32:35], v[56:59], v[36:39]
  s_waitcnt lgkmcnt(2)
  v_add_f32 v112, v112, v113
  v_add_f32 v114, v114, v115
  s_mov_b32 s77, 0
  ds_read_b128 v[56:59], v8 offset:2240
  v_mfma_f32_16x16x32_bf16 v[32:35], a[0:3], v[60:63], v[32:35]
  v_cvt_pk_bf16_f32 v113, v112, v114
  buffer_store_dword v113, v16, s[64:67], s77 offen
  v_mfma_f32_16x16x32_bf16 v[36:39], a[16:19], v[60:63], v[36:39]
  ds_read_b128 v[60:63], v8 offset:1728
  v_mfma_f32_16x16x32_bf16 v[36:39], a[0:3], v[64:67], v[36:39]
  ds_read_b128 v[64:67], v8 offset:3584
  v_mfma_f32_16x16x32_bf16 v[32:35], a[52:55], v[68:71], v[32:35]
  v_mfma_f32_16x16x32_bf16 v[36:39], a[68:71], v[68:71], v[36:39]
  ds_read_b128 v[68:71], v8 offset:3072
  v_mfma_f32_16x16x32_bf16 v[32:35], a[36:39], v[72:75], v[32:35]
  v_mfma_f32_16x16x32_bf16 v[36:39], a[52:55], v[72:75], v[36:39]
  ds_read_b128 v[72:75], v8 offset:2560
  v_mfma_f32_16x16x32_bf16 v[32:35], a[20:23], v[76:79], v[32:35]
  v_mfma_f32_16x16x32_bf16 v[36:39], a[36:39], v[76:79], v[36:39]
  ds_read_b128 v[76:79], v8 offset:2048
  v_mfma_f32_16x16x32_bf16 v[32:35], a[4:7], v[80:83], v[32:35]
  v_mfma_f32_16x16x32_bf16 v[36:39], a[20:23], v[80:83], v[36:39]
  ds_read_b128 v[80:83], v8 offset:1536
  v_mfma_f32_16x16x32_bf16 v[36:39], a[4:7], v[84:87], v[36:39]
  ds_read_b128 v[84:87], v8 offset:1024
  v_mfma_f32_16x16x32_bf16 v[32:35], a[56:59], v[88:91], v[32:35]
  v_mfma_f32_16x16x32_bf16 v[36:39], a[72:75], v[88:91], v[36:39]
  ds_read_b128 v[88:91], v8 offset:512
  v_mfma_f32_16x16x32_bf16 v[32:35], a[40:43], v[92:95], v[32:35]
  v_mfma_f32_16x16x32_bf16 v[36:39], a[56:59], v[92:95], v[36:39]
  ds_read_b128 v[92:95], v8 offset:3648
  v_mfma_f32_16x16x32_bf16 v[32:35], a[24:27], v[96:99], v[32:35]
  v_mfma_f32_16x16x32_bf16 v[36:39], a[40:43], v[96:99], v[36:39]
  ds_read_b128 v[96:99], v8 offset:3136
  v_mfma_f32_16x16x32_bf16 v[32:35], a[8:11], v[100:103], v[32:35]
  v_mfma_f32_16x16x32_bf16 v[36:39], a[24:27], v[100:103], v[36:39]
  ds_read_b128 v[100:103], v8 offset:2624
  s_waitcnt lgkmcnt(13)
  v_mfma_f32_16x16x32_bf16 v[36:39], a[8:11], v[104:107], v[36:39]
  ds_read_b128 v[104:107], v8 offset:2112
  v_mfma_f32_16x16x32_bf16 v[32:35], a[60:63], v[108:111], v[32:35]
  v_mfma_f32_16x16x32_bf16 v[36:39], a[76:79], v[108:111], v[36:39]
  ds_read_b128 v[108:111], v8 offset:1600
  v_mfma_f32_16x16x32_bf16 v[32:35], a[44:47], v[48:51], v[32:35]
  v_mfma_f32_16x16x32_bf16 v[36:39], a[60:63], v[48:51], v[36:39]
  ds_read_b128 v[48:51], v8 offset:1088
  s_waitcnt lgkmcnt(13)
  v_mfma_f32_16x16x32_bf16 v[32:35], a[28:31], v[52:55], v[32:35]
  v_mfma_f32_16x16x32_bf16 v[36:39], a[44:47], v[52:55], v[36:39]
  ds_read_b128 v[52:55], v8 offset:576
  v_mfma_f32_16x16x32_bf16 v[32:35], a[12:15], v[56:59], v[32:35]
  v_mfma_f32_16x16x32_bf16 v[36:39], a[28:31], v[56:59], v[36:39]
  ds_read_b128 v[56:59], v8 offset:3712
  v_mfma_f32_16x16x32_bf16 v[36:39], a[12:15], v[60:63], v[36:39]
  s_nop 4
  ds_write_b128 v12, v[32:35] offset:3072
  s_nop 1
  ds_write_b128 v12, v[36:39] offset:4096
  ds_read_b128 v[60:63], v8 offset:3200
  s_waitcnt lgkmcnt(1)
  s_barrier
  v_mfma_f32_16x16x32_bf16 v[40:43], a[80:83], v[64:67], 0
  ds_read_u16_d16_hi v112, v15 offset:512
  ds_read_u16_d16_hi v113, v15 offset:4608
  ds_read_u16_d16_hi v114, v15 offset:8704
  ds_read_u16_d16_hi v115, v15 offset:12800
  ds_read_u16_d16_hi v116, v15 offset:1024
  ds_read_u16_d16_hi v117, v15 offset:5120
  ds_read_u16_d16_hi v118, v15 offset:9216
  ds_read_u16_d16_hi v119, v15 offset:13312
  v_mfma_f32_16x16x32_bf16 v[44:47], a[96:99], v[64:67], 0
  ds_read_b128 v[64:67], v8 offset:2688
  v_mfma_f32_16x16x32_bf16 v[40:43], a[64:67], v[68:71], v[40:43]
  v_mfma_f32_16x16x32_bf16 v[44:47], a[80:83], v[68:71], v[44:47]
  ds_read_b128 v[68:71], v8 offset:2176
  v_mfma_f32_16x16x32_bf16 v[40:43], a[48:51], v[72:75], v[40:43]
  v_mfma_f32_16x16x32_bf16 v[44:47], a[64:67], v[72:75], v[44:47]
  s_waitcnt lgkmcnt(6)
  v_add_f32 v112, v112, v113
  v_add_f32 v114, v114, v115
  s_mov_b32 s77, 262144
  ds_read_b128 v[72:75], v8 offset:1664
  v_mfma_f32_16x16x32_bf16 v[40:43], a[32:35], v[76:79], v[40:43]
  v_cvt_pk_bf16_f32 v113, v112, v114
  buffer_store_dword v113, v16, s[64:67], s77 offen
  s_waitcnt lgkmcnt(3)
  v_add_f32 v116, v116, v117
  v_mfma_f32_16x16x32_bf16 v[44:47], a[48:51], v[76:79], v[44:47]
  v_add_f32 v118, v118, v119
  s_mov_b32 s77, 524288
  v_cvt_pk_bf16_f32 v117, v116, v118
  buffer_store_dword v117, v16, s[64:67], s77 offen
  ds_read_b128 v[76:79], v8 offset:1152
  v_mfma_f32_16x16x32_bf16 v[40:43], a[16:19], v[80:83], v[40:43]
  v_mfma_f32_16x16x32_bf16 v[44:47], a[32:35], v[80:83], v[44:47]
  ds_read_b128 v[80:83], v8 offset:640
  v_mfma_f32_16x16x32_bf16 v[40:43], a[0:3], v[84:87], v[40:43]
  v_mfma_f32_16x16x32_bf16 v[44:47], a[16:19], v[84:87], v[44:47]
  ds_read_b128 v[84:87], v8 offset:3776
  v_mfma_f32_16x16x32_bf16 v[44:47], a[0:3], v[88:91], v[44:47]
  ds_read_b128 v[88:91], v8 offset:3264
  v_mfma_f32_16x16x32_bf16 v[40:43], a[84:87], v[92:95], v[40:43]
  v_mfma_f32_16x16x32_bf16 v[44:47], a[100:103], v[92:95], v[44:47]
  ds_read_b128 v[92:95], v8 offset:2752
  v_mfma_f32_16x16x32_bf16 v[40:43], a[68:71], v[96:99], v[40:43]
  v_mfma_f32_16x16x32_bf16 v[44:47], a[84:87], v[96:99], v[44:47]
  ds_read_b128 v[96:99], v8 offset:2240
  v_mfma_f32_16x16x32_bf16 v[40:43], a[52:55], v[100:103], v[40:43]
  v_mfma_f32_16x16x32_bf16 v[44:47], a[68:71], v[100:103], v[44:47]
  ds_read_b128 v[100:103], v8 offset:1728
  v_mfma_f32_16x16x32_bf16 v[40:43], a[36:39], v[104:107], v[40:43]
  v_mfma_f32_16x16x32_bf16 v[44:47], a[52:55], v[104:107], v[44:47]
  ds_read_b128 v[104:107], v8 offset:1216
  v_mfma_f32_16x16x32_bf16 v[40:43], a[20:23], v[108:111], v[40:43]
  v_mfma_f32_16x16x32_bf16 v[44:47], a[36:39], v[108:111], v[44:47]
  ds_read_b128 v[108:111], v8 offset:704
  v_mfma_f32_16x16x32_bf16 v[40:43], a[4:7], v[48:51], v[40:43]
  v_mfma_f32_16x16x32_bf16 v[44:47], a[20:23], v[48:51], v[44:47]
  ds_read_b128 v[48:51], v8 offset:3584
  v_mfma_f32_16x16x32_bf16 v[44:47], a[4:7], v[52:55], v[44:47]
  ds_read_b128 v[52:55], v8 offset:3072
  v_mfma_f32_16x16x32_bf16 v[40:43], a[88:91], v[56:59], v[40:43]
  v_mfma_f32_16x16x32_bf16 v[44:47], a[104:107], v[56:59], v[44:47]
  ds_read_b128 v[56:59], v8 offset:2560
  s_waitcnt lgkmcnt(13)
  v_mfma_f32_16x16x32_bf16 v[40:43], a[72:75], v[60:63], v[40:43]
  v_mfma_f32_16x16x32_bf16 v[44:47], a[88:91], v[60:63], v[44:47]
  ds_read_b128 v[60:63], v8 offset:2048
  v_mfma_f32_16x16x32_bf16 v[40:43], a[56:59], v[64:67], v[40:43]
  v_mfma_f32_16x16x32_bf16 v[44:47], a[72:75], v[64:67], v[44:47]
  ds_read_b128 v[64:67], v8 offset:1536
  v_mfma_f32_16x16x32_bf16 v[40:43], a[40:43], v[68:71], v[40:43]
  v_mfma_f32_16x16x32_bf16 v[44:47], a[56:59], v[68:71], v[44:47]
  ds_read_b128 v[68:71], v8 offset:1024
  s_waitcnt lgkmcnt(13)
  v_mfma_f32_16x16x32_bf16 v[40:43], a[24:27], v[72:75], v[40:43]
  v_mfma_f32_16x16x32_bf16 v[44:47], a[40:43], v[72:75], v[44:47]
  ds_read_b128 v[72:75], v8 offset:512
  v_mfma_f32_16x16x32_bf16 v[40:43], a[8:11], v[76:79], v[40:43]
  v_mfma_f32_16x16x32_bf16 v[44:47], a[24:27], v[76:79], v[44:47]
  ds_read_b128 v[76:79], v8 offset:0
  v_mfma_f32_16x16x32_bf16 v[44:47], a[8:11], v[80:83], v[44:47]
  ds_read_b128 v[80:83], v8 offset:3648
  s_waitcnt lgkmcnt(13)
  v_mfma_f32_16x16x32_bf16 v[40:43], a[92:95], v[84:87], v[40:43]
  v_mfma_f32_16x16x32_bf16 v[44:47], a[108:111], v[84:87], v[44:47]
  ds_read_b128 v[84:87], v8 offset:3136
  v_mfma_f32_16x16x32_bf16 v[40:43], a[76:79], v[88:91], v[40:43]
  v_mfma_f32_16x16x32_bf16 v[44:47], a[92:95], v[88:91], v[44:47]
  ds_read_b128 v[88:91], v8 offset:2624
  v_mfma_f32_16x16x32_bf16 v[40:43], a[60:63], v[92:95], v[40:43]
  v_mfma_f32_16x16x32_bf16 v[44:47], a[76:79], v[92:95], v[44:47]
  ds_read_b128 v[92:95], v8 offset:2112
  s_waitcnt lgkmcnt(13)
  v_mfma_f32_16x16x32_bf16 v[40:43], a[44:47], v[96:99], v[40:43]
  v_mfma_f32_16x16x32_bf16 v[44:47], a[60:63], v[96:99], v[44:47]
  ds_read_b128 v[96:99], v8 offset:1600
  v_mfma_f32_16x16x32_bf16 v[40:43], a[28:31], v[100:103], v[40:43]
  v_mfma_f32_16x16x32_bf16 v[44:47], a[44:47], v[100:103], v[44:47]
  ds_read_b128 v[100:103], v8 offset:1088
  v_mfma_f32_16x16x32_bf16 v[40:43], a[12:15], v[104:107], v[40:43]
  v_mfma_f32_16x16x32_bf16 v[44:47], a[28:31], v[104:107], v[44:47]
  ds_read_b128 v[104:107], v8 offset:576
  s_waitcnt lgkmcnt(13)
  v_mfma_f32_16x16x32_bf16 v[44:47], a[12:15], v[108:111], v[44:47]
  s_nop 3
  ds_write_b128 v12, v[40:43] offset:5120
  s_nop 2
  ds_write_b128 v12, v[44:47] offset:6144
  ds_read_b128 v[108:111], v8 offset:64
  s_waitcnt lgkmcnt(1)
  s_barrier
  v_mfma_f32_16x16x32_bf16 v[32:35], a[112:115], v[48:51], 0
  ds_read_u16_d16_hi v112, v15 offset:1536
  ds_read_u16_d16_hi v113, v15 offset:5632
  ds_read_u16_d16_hi v114, v15 offset:9728
  ds_read_u16_d16_hi v115, v15 offset:13824
  ds_read_u16_d16_hi v116, v15 offset:2048
  ds_read_u16_d16_hi v117, v15 offset:6144
  ds_read_u16_d16_hi v118, v15 offset:10240
  ds_read_u16_d16_hi v119, v15 offset:14336
  ds_read_b128 v[48:51], v8 offset:3712
  v_mfma_f32_16x16x32_bf16 v[32:35], a[96:99], v[52:55], v[32:35]
  ds_read_b128 v[52:55], v8 offset:3200
  v_mfma_f32_16x16x32_bf16 v[32:35], a[80:83], v[56:59], v[32:35]
  ds_read_b128 v[56:59], v8 offset:2688
  v_mfma_f32_16x16x32_bf16 v[32:35], a[64:67], v[60:63], v[32:35]
  ds_read_b128 v[60:63], v8 offset:2176
  v_mfma_f32_16x16x32_bf16 v[32:35], a[48:51], v[64:67], v[32:35]
  ds_read_b128 v[64:67], v8 offset:1664
  v_mfma_f32_16x16x32_bf16 v[32:35], a[32:35], v[68:71], v[32:35]
  s_waitcnt lgkmcnt(9)
  v_add_f32 v112, v112, v113
  v_add_f32 v114, v114, v115
  s_mov_b32 s77, 786432
  ds_read_b128 v[68:71], v8 offset:1152
  v_mfma_f32_16x16x32_bf16 v[32:35], a[16:19], v[72:75], v[32:35]
  v_cvt_pk_bf16_f32 v113, v112, v114
  buffer_store_dword v113, v16, s[64:67], s77 offen
  s_waitcnt lgkmcnt(6)
  v_add_f32 v116, v116, v117
  ds_read_b128 v[72:75], v8 offset:640
  v_mfma_f32_16x16x32_bf16 v[32:35], a[0:3], v[76:79], v[32:35]
  v_add_f32 v118, v118, v119
  s_mov_b32 s77, 1048576
  v_cvt_pk_bf16_f32 v117, v116, v118
  buffer_store_dword v117, v16, s[64:67], s77 offen
  ds_read_b128 v[76:79], v8 offset:128
  v_mfma_f32_16x16x32_bf16 v[32:35], a[116:119], v[80:83], v[32:35]
  ds_read_b128 v[80:83], v8 offset:3776
  v_mfma_f32_16x16x32_bf16 v[32:35], a[100:103], v[84:87], v[32:35]
  ds_read_b128 v[84:87], v8 offset:3264
  v_mfma_f32_16x16x32_bf16 v[32:35], a[84:87], v[88:91], v[32:35]
  ds_read_b128 v[88:91], v8 offset:2752
  v_mfma_f32_16x16x32_bf16 v[32:35], a[68:71], v[92:95], v[32:35]
  ds_read_b128 v[92:95], v8 offset:2240
  v_mfma_f32_16x16x32_bf16 v[32:35], a[52:55], v[96:99], v[32:35]
  ds_read_b128 v[96:99], v8 offset:1728
  v_mfma_f32_16x16x32_bf16 v[32:35], a[36:39], v[100:103], v[32:35]
  ds_read_b128 v[100:103], v8 offset:1216
  s_waitcnt lgkmcnt(13)
  v_mfma_f32_16x16x32_bf16 v[32:35], a[20:23], v[104:107], v[32:35]
  ds_read_b128 v[104:107], v8 offset:704
  v_mfma_f32_16x16x32_bf16 v[32:35], a[4:7], v[108:111], v[32:35]
  ds_read_b128 v[108:111], v8 offset:192
  v_mfma_f32_16x16x32_bf16 v[32:35], a[120:123], v[48:51], v[32:35]
  s_waitcnt lgkmcnt(12)
  v_mfma_f32_16x16x32_bf16 v[32:35], a[104:107], v[52:55], v[32:35]
  v_mfma_f32_16x16x32_bf16 v[32:35], a[88:91], v[56:59], v[32:35]
  v_mfma_f32_16x16x32_bf16 v[32:35], a[72:75], v[60:63], v[32:35]
  s_waitcnt lgkmcnt(9)
  v_mfma_f32_16x16x32_bf16 v[32:35], a[56:59], v[64:67], v[32:35]
  v_mfma_f32_16x16x32_bf16 v[32:35], a[40:43], v[68:71], v[32:35]
  v_mfma_f32_16x16x32_bf16 v[32:35], a[24:27], v[72:75], v[32:35]
  s_waitcnt lgkmcnt(6)
  v_mfma_f32_16x16x32_bf16 v[32:35], a[8:11], v[76:79], v[32:35]
  v_mfma_f32_16x16x32_bf16 v[32:35], a[124:127], v[80:83], v[32:35]
  v_mfma_f32_16x16x32_bf16 v[32:35], a[108:111], v[84:87], v[32:35]
  s_waitcnt lgkmcnt(3)
  v_mfma_f32_16x16x32_bf16 v[32:35], a[92:95], v[88:91], v[32:35]
  v_mfma_f32_16x16x32_bf16 v[32:35], a[76:79], v[92:95], v[32:35]
  v_mfma_f32_16x16x32_bf16 v[32:35], a[60:63], v[96:99], v[32:35]
  s_waitcnt lgkmcnt(0)
  v_mfma_f32_16x16x32_bf16 v[32:35], a[44:47], v[100:103], v[32:35]
  v_mfma_f32_16x16x32_bf16 v[32:35], a[28:31], v[104:107], v[32:35]
  v_mfma_f32_16x16x32_bf16 v[32:35], a[12:15], v[108:111], v[32:35]
  s_nop 7
  ds_write_b128 v12, v[32:35] offset:7168
  s_waitcnt lgkmcnt(0)
  s_barrier
  ds_read_u16_d16_hi v112, v15 offset:2560
  ds_read_u16_d16_hi v113, v15 offset:6656
  ds_read_u16_d16_hi v114, v15 offset:10752
  ds_read_u16_d16_hi v115, v15 offset:14848
  ds_read_u16_d16_hi v116, v15 offset:3072
  ds_read_u16_d16_hi v117, v15 offset:7168
  ds_read_u16_d16_hi v118, v15 offset:11264
  ds_read_u16_d16_hi v119, v15 offset:15360
  s_waitcnt lgkmcnt(4)
  v_add_f32 v112, v112, v113
  v_add_f32 v114, v114, v115
  s_mov_b32 s77, 1310720
  v_cvt_pk_bf16_f32 v113, v112, v114
  buffer_store_dword v113, v16, s[64:67], s77 offen
  s_waitcnt lgkmcnt(0)
  v_add_f32 v116, v116, v117
  v_add_f32 v118, v118, v119
  s_mov_b32 s77, 1572864
  v_cvt_pk_bf16_f32 v117, v116, v118
  buffer_store_dword v117, v16, s[64:67], s77 offen
  s_barrier
  ds_read_u16_d16_hi v112, v15 offset:3584
  ds_read_u16_d16_hi v113, v15 offset:7680
  ds_read_u16_d16_hi v114, v15 offset:11776
  ds_read_u16_d16_hi v115, v15 offset:15872
  s_waitcnt lgkmcnt(0)
  v_add_f32 v112, v112, v113
  v_add_f32 v114, v114, v115
  s_mov_b32 s77, 1835008
  v_cvt_pk_bf16_f32 v113, v112, v114
  buffer_store_dword v113, v16, s[64:67], s77 offen
L_END:
  s_endpgm
L_CODE_END:
.section .rodata,"a"
.p2align 6
.amdhsa_kernel gated_mix__ssm_conv_h3__ssm_conv_s4__prompt_kernel
  .amdhsa_next_free_vgpr 256
  .amdhsa_next_free_sgpr 102
  .amdhsa_accum_offset 128
  .amdhsa_group_segment_fixed_size 0
  .amdhsa_kernarg_size 152
  .amdhsa_user_sgpr_count 2
  .amdhsa_user_sgpr_kernarg_segment_ptr 1
  .amdhsa_system_sgpr_workgroup_id_x 1
.end_amdhsa_kernel
```
